```python
import torch

def _softmax(x, axis=-1):
    return torch.softmax(x, dim=axis)
def _gelu(x):
    return torch.nn.functional.gelu(x, approximate="tanh")
def _silu(x):
    return torch.nn.functional.silu(x)
def _sigmoid(x):
    return torch.sigmoid(x)
def _layernorm(x, axis=-1, eps=1e-5):
    m = x.mean(dim=axis, keepdim=True)
    v = x.var(dim=axis, keepdim=True, unbiased=False)
    return (x - m) / torch.sqrt(v + eps)
def _scatter_add(tgt, idx, src, axis=0):
    return tgt.clone().index_add_(axis, idx, src)
def _segment_sum(src, seg, n):
    out = torch.zeros((n,) + src.shape[1:], dtype=src.dtype)
    return out.index_add_(0, seg, src)
def _pad(x, pw):
    flat = tuple(v for pair in reversed(pw) for v in pair)
    return torch.nn.functional.pad(x, flat)

kernel_name = 'gated_mix__ssm_conv_s4__geglu_ffn__prompt'

def setup_inputs():

    _w = (lambda a: (lambda t: t.to(torch.bfloat16) if t.is_floating_point() else t)(torch.as_tensor(a)))
    def _A_setup():
        B, L, D, N = 1, 2048, 512, 128
        A_re = -(lambda _x: torch.exp(torch.as_tensor(_x)))((lambda *s: torch.randn(*s, dtype=torch.bfloat16) * 6.4)(D, N))
        A_im = torch.pi * (lambda *s: torch.randn(*s, dtype=torch.bfloat16) * 0.05)(D, N)
        B_re = (lambda *s: torch.randn(*s, dtype=torch.bfloat16) * 0.1)(D, N)
        B_im = (lambda *s: torch.randn(*s, dtype=torch.bfloat16) * 0.1)(D, N)
        C_re = (lambda *s: torch.randn(*s, dtype=torch.bfloat16) * 0.1)(D, N)
        C_im = (lambda *s: torch.randn(*s, dtype=torch.bfloat16) * 0.1)(D, N)
        log_dt = (lambda *s: torch.randn(*s, dtype=torch.bfloat16) * 0.05)(D) * 0.5 - 4.0
        Dskip = (lambda *s: torch.randn(*s, dtype=torch.bfloat16) * 0.05)(D)
        return {
            "u": _w((lambda *s: torch.randn(*s, dtype=torch.bfloat16) * 0.05)(B, L, D)),
            "A_re": _w(A_re),
            "A_im": _w(A_im),
            "B_re": _w(B_re),
            "B_im": _w(B_im),
            "C_re": _w(C_re),
            "C_im": _w(C_im),
            "log_dt": _w(log_dt),
            "Dskip": _w(Dskip),
        }
    _A_in = _A_setup()

    def _B_setup():
        B, S, D, F = 1, 2048, 512, 1376
        return {
            "x": _w((lambda *s: torch.randn(*s, dtype=torch.bfloat16) * 0.05)(B, S, D)),
            "w_gate": _w((lambda *s: torch.randn(*s, dtype=torch.bfloat16) * 0.05)(D, F)),
            "w_up": _w((lambda *s: torch.randn(*s, dtype=torch.bfloat16) * 0.05)(D, F)),
            "w_down": _w((lambda *s: torch.randn(*s, dtype=torch.bfloat16) * 0.05)(F, D)),
        }
    _B_in = _B_setup()

    return {
        "A_u": _A_in["u"],
        "A_A_re": _A_in["A_re"],
        "A_A_im": _A_in["A_im"],
        "A_B_re": _A_in["B_re"],
        "A_B_im": _A_in["B_im"],
        "A_C_re": _A_in["C_re"],
        "A_C_im": _A_in["C_im"],
        "A_log_dt": _A_in["log_dt"],
        "A_Dskip": _A_in["Dskip"],
        "B_x": _B_in["x"],
        "B_w_gate": _B_in["w_gate"],
        "B_w_up": _B_in["w_up"],
        "B_w_down": _B_in["w_down"],
        "gate_w": _w((lambda *s: torch.randn(*s, dtype=torch.bfloat16) * 0.05)(512) * 16.0),
    }

def reference(A_u, A_A_re, A_A_im, A_B_re, A_B_im, A_C_re, A_C_im, A_log_dt, A_Dskip, B_x, B_w_gate, B_w_up, B_w_down, gate_w):
    def _A_ref(u, A_re, A_im, B_re, B_im, C_re, C_im, log_dt, Dskip):
        Bsz, L, D = u.shape
        dt = torch.exp(log_dt)[:, None]
        A = A_re + 1j * A_im
        Bc = B_re + 1j * B_im
        Cc = C_re + 1j * C_im
        logdA = dt * A
        dB = dt * Bc
        l = (lambda x, dt: x.to(dt))(torch.arange(L), A_re.dtype)
        P = torch.exp(logdA[:, :, None] * l[None, None, :])
        K = torch.einsum("dn,dnl,dn->dl", Cc, P, dB).real
        L2 = 2 * L
        Kp = _pad(K, ((0, 0), (0, L)))
        up = (lambda x, *d: x.permute(*d))(u, 0, 2, 1)
        up = _pad(up, ((0, 0), (0, 0), (0, L)))
        Kf = (lambda x, axes=(-2,-1): torch.fft.rfft2(x.float(), dim=axes))(Kp[:, None, :], axes=(-2, -1))
        Uf = (lambda x, axes=(-2,-1): torch.fft.rfft2(x.float(), dim=axes))(up[:, :, None, :], axes=(-2, -1))
        Yf = Uf * Kf[None, :, :, :]
        y = (lambda x, s, axes=(-2,-1): torch.fft.irfft2(x, s=s, dim=axes).to(torch.bfloat16))(Yf, (1, L2), axes=(-2, -1))[:, :, 0, :L]
        y = (lambda x, *d: x.permute(*d))(y, 0, 2, 1) + u * Dskip[None, None, :]
        return y

    def _B_ref(x, w_gate, w_up, w_down):
        return (_gelu(x @ w_gate) * (x @ w_up)) @ w_down

    x = A_u
    g = _sigmoid((x * gate_w).sum(-1, keepdims=True))
    a = _A_ref(x, A_A_re, A_A_im, A_B_re, A_B_im, A_C_re, A_C_im, A_log_dt, A_Dskip)
    b = _B_ref(x, B_w_gate, B_w_up, B_w_down)
    return g * a + (1 - g) * b
```

```asm
; @launch grid=(256,1,1) block=(512,1,1) lds=163840
.amdgcn_target "amdgcn-amd-amdhsa--gfx950"
.text
.globl gated_mix__ssm_conv_s4__geglu_ffn__prompt_kernel
.p2align 8
.type gated_mix__ssm_conv_s4__geglu_ffn__prompt_kernel,@function
gated_mix__ssm_conv_s4__geglu_ffn__prompt_kernel:
    s_cmp_ge_u32 s2, 256
    s_cbranch_scc1 K_done
    s_load_dwordx16 s[16:31], s[0:1], 0
    s_load_dwordx16 s[32:47], s[0:1], 64
    s_load_dwordx2 s[48:49], s[0:1], 128
    v_lshrrev_b32 v1, 6, v0
    v_and_b32 v0, 63, v0
    v_readfirstlane_b32 s3, v1
    s_and_b32 s4, s2, 7
    s_lshr_b32 s5, s2, 3
    s_lshr_b32 s6, s4, 2
    s_lshl_b32 s6, s6, 3
    s_and_b32 s8, s5, 7
    s_add_u32 s6, s6, s8
    s_and_b32 s7, s4, 3
    s_lshl_b32 s7, s7, 2
    s_lshr_b32 s8, s5, 3
    s_add_u32 s7, s7, s8
    s_lshr_b32 s71, s5, 2
    s_lshl_b32 s72, s4, 6
    s_lshl_b32 s8, s5, 1
    s_add_u32 s72, s72, s8
    s_cmp_eq_u32 s7, 15
    s_cbranch_scc1 K_helper
    s_cmp_lt_u32 s3, 4
    s_cbranch_scc1 K_gemm
    s_lshr_b32 s99, s5, 3
    s_lshl_b32 s99, s99, 1
    s_add_u32 s99, s99, s5
    s_lshl_b32 s73, s99, 1
    s_sub_u32 s54, s3, 4
    s_lshl_b32 s8, s6, 7
    s_lshl_b32 s9, s54, 5
    s_add_u32 s8, s8, s9
    s_lshl_b32 s8, s8, 10
    v_lshrrev_b32 v9, 3, v0
    v_lshlrev_b32 v9, 10, v9
    v_add_u32 v9, s8, v9
    v_and_b32 v10, 7, v0
    v_lshrrev_b32 v11, 4, v0
    v_xor_b32 v10, v10, v11
    v_xor_b32 v11, 4, v10
    v_lshl_add_u32 v155, v10, 4, v9
    v_add_u32 v155, 0, v155
    v_lshl_add_u32 v156, v11, 4, v9
    v_add_u32 v156, 8192, v156
    v_lshl_add_u32 v157, v10, 4, v9
    v_add_u32 v157, 16384, v157
    v_lshl_add_u32 v158, v11, 4, v9
    v_add_u32 v158, 24576, v158
    s_and_b32 s8, s54, 1
    s_mul_i32 s8, s8, 192
    s_mul_i32 s9, s7, 192
    v_add_u32 v9, s8, v0
    v_add_u32 v9, 0, v9
    v_mul_u32_u24 v10, 43691, v9
    v_lshrrev_b32 v10, 19, v10
    v_mul_u32_u24 v11, 12, v10
    v_sub_u32 v11, v9, v11
    v_mul_u32_u24 v10, 2752, v10
    v_lshl_add_u32 v10, v11, 4, v10
    v_add_u32 v152, s9, v10
    v_add_u32 v9, s8, v0
    v_add_u32 v9, 64, v9
    v_mul_u32_u24 v10, 43691, v9
    v_lshrrev_b32 v10, 19, v10
    v_mul_u32_u24 v11, 12, v10
    v_sub_u32 v11, v9, v11
    v_mul_u32_u24 v10, 2752, v10
    v_lshl_add_u32 v10, v11, 4, v10
    v_add_u32 v153, s9, v10
    v_add_u32 v9, s8, v0
    v_add_u32 v9, 128, v9
    v_mul_u32_u24 v10, 43691, v9
    v_lshrrev_b32 v10, 19, v10
    v_mul_u32_u24 v11, 12, v10
    v_sub_u32 v11, v9, v11
    v_mul_u32_u24 v10, 2752, v10
    v_lshl_add_u32 v10, v11, 4, v10
    v_add_u32 v154, s9, v10
    s_lshr_b32 s8, s54, 1
    s_mul_i32 s50, s8, 6176
    s_and_b32 s9, s54, 1
    s_mul_i32 s9, s9, 3072
    s_add_u32 s50, s50, s9
    s_add_u32 s50, s50, 49152
    s_lshl_b32 s51, s54, 12
    s_waitcnt lgkmcnt(0)
    s_cmp_eq_u32 s8, 0
    s_cselect_b32 s12, s36, s38
    s_cselect_b32 s13, s37, s39
    s_mov_b32 s14, 1409024
    s_mov_b32 s15, 0x20000
    s_mov_b32 s8, s16
    s_mov_b32 s9, s17
    s_mov_b32 s10, 0x200000
    s_mov_b32 s11, 0x20000
    s_add_u32 s52, s99, 0
    s_and_b32 s52, s52, 7
    s_lshl_b32 s52, s52, 7
    s_add_u32 m0, s51, 0
    s_nop 0
    buffer_load_dwordx4 v155, s[8:11], s52 offen lds
    s_add_u32 m0, s51, 1024
    s_nop 0
    buffer_load_dwordx4 v156, s[8:11], s52 offen lds
    s_add_u32 m0, s51, 2048
    s_nop 0
    buffer_load_dwordx4 v157, s[8:11], s52 offen lds
    s_add_u32 m0, s51, 3072
    s_nop 0
    buffer_load_dwordx4 v158, s[8:11], s52 offen lds
    s_add_u32 s53, s73, 0
    s_and_b32 s53, s53, 15
    s_mul_i32 s53, s53, 88064
    s_add_u32 m0, s50, 0
    s_nop 0
    buffer_load_dwordx4 v152, s[12:15], s53 offen lds
    s_add_u32 m0, s50, 1024
    s_nop 0
    buffer_load_dwordx4 v153, s[12:15], s53 offen lds
    s_add_u32 m0, s50, 2048
    s_nop 0
    buffer_load_dwordx4 v154, s[12:15], s53 offen lds
    s_add_u32 s53, s73, 1
    s_and_b32 s53, s53, 15
    s_mul_i32 s53, s53, 88064
    s_add_u32 m0, s50, 12320
    s_nop 0
    buffer_load_dwordx4 v152, s[12:15], s53 offen lds
    s_add_u32 m0, s50, 13344
    s_nop 0
    buffer_load_dwordx4 v153, s[12:15], s53 offen lds
    s_add_u32 m0, s50, 14368
    s_nop 0
    buffer_load_dwordx4 v154, s[12:15], s53 offen lds
    s_lshl_b32 s55, s72, 8
    s_lshl_b32 s56, s54, 7
    s_add_u32 s55, s55, s56
    v_lshl_add_u32 v1, v0, 1, s55
    s_lshl_b32 s55, s72, 1
    s_load_dword s57, s[30:31], s55
    global_load_ushort v2, v1, s[18:19]
    global_load_ushort v3, v1, s[20:21]
    global_load_ushort v4, v1, s[22:23]
    global_load_ushort v5, v1, s[24:25]
    global_load_ushort v6, v1, s[26:27]
    global_load_ushort v7, v1, s[28:29]
    s_and_b32 s68, s54, 1
    s_lshl_b32 s68, s68, 10
    s_sub_u32 s68, 2040, s68
    s_lshr_b32 s69, s54, 1
    s_mul_i32 s69, s69, 29184
    s_add_u32 s69, s69, 98560
    v_lshlrev_b32 v56, 3, v0
    v_sub_u32 v241, s68, v56
    v_or_b32 v57, 1, v241
    v_cvt_f32_u32 v57, v57
    v_lshrrev_b32 v57, 23, v57
    v_subrev_u32 v57, 134, v57
    v_max_i32 v60, 0, v57
    v_lshlrev_b32 v58, v60, 4
    v_add_u32 v61, 150, v60
    v_lshlrev_b32 v61, 23, v61
    v_or_b32 v61, 0x400000, v61
    v_mul_u32_u24 v59, v61, v58
    v_sub_u32 v59, 0, v59
    v_cvt_f32_u32 v57, v241
    v_add_f32 v57, v57, v61
    v_subrev_u32 v62, 1, v241
    v_max_i32 v62, 0, v62
    v_cvt_f32_u32 v62, v62
    v_cvt_pk_bf16_f32 v62, v62, v62
    v_lshlrev_b32 v62, 16, v62
    v_cvt_u32_f32 v62, v62
    v_lshrrev_b32 v63, 3, v62
    v_add_u32 v62, v62, v63
    v_lshl_add_u32 v240, v62, 2, s69
    v_add_f32 v232, 0x40e00000, v57
    v_mad_u32_u24 v232, v232, v58, v59
    v_lshrrev_b32 v63, 5, v232
    v_lshl_add_u32 v63, v63, 2, s69
    v_add_u32 v232, v232, v63
    v_add_f32 v233, 0x40c00000, v57
    v_mad_u32_u24 v233, v233, v58, v59
    v_lshrrev_b32 v63, 5, v233
    v_lshl_add_u32 v63, v63, 2, s69
    v_add_u32 v233, v233, v63
    v_add_f32 v234, 0x40a00000, v57
    v_mad_u32_u24 v234, v234, v58, v59
    v_lshrrev_b32 v63, 5, v234
    v_lshl_add_u32 v63, v63, 2, s69
    v_add_u32 v234, v234, v63
    v_add_f32 v235, 0x40800000, v57
    v_mad_u32_u24 v235, v235, v58, v59
    v_lshrrev_b32 v63, 5, v235
    v_lshl_add_u32 v63, v63, 2, s69
    v_add_u32 v235, v235, v63
    v_add_f32 v236, 0x40400000, v57
    v_mad_u32_u24 v236, v236, v58, v59
    v_lshrrev_b32 v63, 5, v236
    v_lshl_add_u32 v63, v63, 2, s69
    v_add_u32 v236, v236, v63
    v_add_f32 v237, 0x40000000, v57
    v_mad_u32_u24 v237, v237, v58, v59
    v_lshrrev_b32 v63, 5, v237
    v_lshl_add_u32 v63, v63, 2, s69
    v_add_u32 v237, v237, v63
    v_add_f32 v238, 0x3f800000, v57
    v_mad_u32_u24 v238, v238, v58, v59
    v_lshrrev_b32 v63, 5, v238
    v_lshl_add_u32 v63, v63, 2, s69
    v_add_u32 v238, v238, v63
    v_add_f32 v239, 0x00000000, v57
    v_mad_u32_u24 v239, v239, v58, v59
    v_lshrrev_b32 v63, 5, v239
    v_lshl_add_u32 v63, v63, 2, s69
    v_add_u32 v239, v239, v63
    s_and_b32 s68, s54, 1
    s_lshl_b32 s68, s68, 10
    s_sub_u32 s68, 1528, s68
    s_lshr_b32 s69, s54, 1
    s_mul_i32 s69, s69, 29184
    s_add_u32 s69, s69, 98560
    v_lshlrev_b32 v56, 3, v0
    v_sub_u32 v251, s68, v56
    v_or_b32 v57, 1, v251
    v_cvt_f32_u32 v57, v57
    v_lshrrev_b32 v57, 23, v57
    v_subrev_u32 v57, 134, v57
    v_max_i32 v60, 0, v57
    v_lshlrev_b32 v58, v60, 4
    v_add_u32 v61, 150, v60
    v_lshlrev_b32 v61, 23, v61
    v_or_b32 v61, 0x400000, v61
    v_mul_u32_u24 v59, v61, v58
    v_sub_u32 v59, 0, v59
    v_cvt_f32_u32 v57, v251
    v_add_f32 v57, v57, v61
    v_subrev_u32 v62, 1, v251
    v_max_i32 v62, 0, v62
    v_cvt_f32_u32 v62, v62
    v_cvt_pk_bf16_f32 v62, v62, v62
    v_lshlrev_b32 v62, 16, v62
    v_cvt_u32_f32 v62, v62
    v_lshrrev_b32 v63, 3, v62
    v_add_u32 v62, v62, v63
    v_lshl_add_u32 v250, v62, 2, s69
    v_add_f32 v242, 0x40e00000, v57
    v_mad_u32_u24 v242, v242, v58, v59
    v_lshrrev_b32 v63, 5, v242
    v_lshl_add_u32 v63, v63, 2, s69
    v_add_u32 v242, v242, v63
    v_add_f32 v243, 0x40c00000, v57
    v_mad_u32_u24 v243, v243, v58, v59
    v_lshrrev_b32 v63, 5, v243
    v_lshl_add_u32 v63, v63, 2, s69
    v_add_u32 v243, v243, v63
    v_add_f32 v244, 0x40a00000, v57
    v_mad_u32_u24 v244, v244, v58, v59
    v_lshrrev_b32 v63, 5, v244
    v_lshl_add_u32 v63, v63, 2, s69
    v_add_u32 v244, v244, v63
    v_add_f32 v245, 0x40800000, v57
    v_mad_u32_u24 v245, v245, v58, v59
    v_lshrrev_b32 v63, 5, v245
    v_lshl_add_u32 v63, v63, 2, s69
    v_add_u32 v245, v245, v63
    v_add_f32 v246, 0x40400000, v57
    v_mad_u32_u24 v246, v246, v58, v59
    v_lshrrev_b32 v63, 5, v246
    v_lshl_add_u32 v63, v63, 2, s69
    v_add_u32 v246, v246, v63
    v_add_f32 v247, 0x40000000, v57
    v_mad_u32_u24 v247, v247, v58, v59
    v_lshrrev_b32 v63, 5, v247
    v_lshl_add_u32 v63, v63, 2, s69
    v_add_u32 v247, v247, v63
    v_add_f32 v248, 0x3f800000, v57
    v_mad_u32_u24 v248, v248, v58, v59
    v_lshrrev_b32 v63, 5, v248
    v_lshl_add_u32 v63, v63, 2, s69
    v_add_u32 v248, v248, v63
    v_add_f32 v249, 0x00000000, v57
    v_mad_u32_u24 v249, v249, v58, v59
    v_lshrrev_b32 v63, 5, v249
    v_lshl_add_u32 v63, v63, 2, s69
    v_add_u32 v249, v249, v63
    s_waitcnt vmcnt(6)
    s_barrier
    s_add_u32 s52, s99, 1
    s_and_b32 s52, s52, 7
    s_lshl_b32 s52, s52, 7
    s_add_u32 m0, s51, 16384
    s_nop 0
    buffer_load_dwordx4 v155, s[8:11], s52 offen lds
    s_add_u32 m0, s51, 17408
    s_nop 0
    buffer_load_dwordx4 v156, s[8:11], s52 offen lds
    s_add_u32 m0, s51, 18432
    s_nop 0
    buffer_load_dwordx4 v157, s[8:11], s52 offen lds
    s_add_u32 m0, s51, 19456
    s_nop 0
    buffer_load_dwordx4 v158, s[8:11], s52 offen lds
    s_add_u32 s53, s73, 2
    s_and_b32 s53, s53, 15
    s_mul_i32 s53, s53, 88064
    s_add_u32 m0, s50, 24640
    s_nop 0
    buffer_load_dwordx4 v152, s[12:15], s53 offen lds
    s_add_u32 m0, s50, 25664
    s_nop 0
    buffer_load_dwordx4 v153, s[12:15], s53 offen lds
    s_add_u32 m0, s50, 26688
    s_nop 0
    buffer_load_dwordx4 v154, s[12:15], s53 offen lds
    s_add_u32 s53, s73, 3
    s_and_b32 s53, s53, 15
    s_mul_i32 s53, s53, 88064
    s_add_u32 m0, s50, 36960
    s_nop 0
    buffer_load_dwordx4 v152, s[12:15], s53 offen lds
    s_add_u32 m0, s50, 37984
    s_nop 0
    buffer_load_dwordx4 v153, s[12:15], s53 offen lds
    s_add_u32 m0, s50, 39008
    s_nop 0
    buffer_load_dwordx4 v154, s[12:15], s53 offen lds
    s_add_u32 s52, s99, 2
    s_and_b32 s52, s52, 7
    s_lshl_b32 s52, s52, 7
    s_add_u32 m0, s51, 32768
    s_nop 0
    buffer_load_dwordx4 v155, s[8:11], s52 offen lds
    s_add_u32 m0, s51, 33792
    s_nop 0
    buffer_load_dwordx4 v156, s[8:11], s52 offen lds
    s_add_u32 m0, s51, 34816
    s_nop 0
    buffer_load_dwordx4 v157, s[8:11], s52 offen lds
    s_add_u32 m0, s51, 35840
    s_nop 0
    buffer_load_dwordx4 v158, s[8:11], s52 offen lds
    s_add_u32 s53, s73, 4
    s_and_b32 s53, s53, 15
    s_mul_i32 s53, s53, 88064
    s_add_u32 m0, s50, 49280
    s_nop 0
    buffer_load_dwordx4 v152, s[12:15], s53 offen lds
    s_add_u32 m0, s50, 50304
    s_nop 0
    buffer_load_dwordx4 v153, s[12:15], s53 offen lds
    s_add_u32 m0, s50, 51328
    s_nop 0
    buffer_load_dwordx4 v154, s[12:15], s53 offen lds
    s_add_u32 s53, s73, 5
    s_and_b32 s53, s53, 15
    s_mul_i32 s53, s53, 88064
    s_add_u32 m0, s50, 61600
    s_nop 0
    buffer_load_dwordx4 v152, s[12:15], s53 offen lds
    s_add_u32 m0, s50, 62624
    s_nop 0
    buffer_load_dwordx4 v153, s[12:15], s53 offen lds
    s_add_u32 m0, s50, 63648
    s_nop 0
    buffer_load_dwordx4 v154, s[12:15], s53 offen lds
    s_waitcnt vmcnt(10)
    s_barrier
    s_add_u32 s52, s99, 3
    s_and_b32 s52, s52, 7
    s_lshl_b32 s52, s52, 7
    s_add_u32 m0, s51, 0
    s_nop 0
    buffer_load_dwordx4 v155, s[8:11], s52 offen lds
    s_mul_i32 s59, s54, 14592
    s_add_u32 s59, s59, 98560
    v_lshl_add_u32 v50, v0, 2, s59
    v_and_b32 v54, 31, v0
    s_add_u32 m0, s51, 1024
    s_nop 0
    buffer_load_dwordx4 v156, s[8:11], s52 offen lds
    v_lshrrev_b32 v55, 5, v0
    v_mul_u32_u24 v52, 272, v54
    v_lshl_add_u32 v52, v55, 4, v52
    v_add_u32 v52, s59, v52
    s_add_u32 m0, s51, 2048
    s_nop 0
    buffer_load_dwordx4 v157, s[8:11], s52 offen lds
    v_min_u32 v56, 20, v54
    v_mul_u32_u24 v51, 272, v56
    v_lshl_add_u32 v51, v55, 4, v51
    v_add_u32 v51, s59, v51
    s_add_u32 m0, s51, 3072
    s_nop 0
    buffer_load_dwordx4 v158, s[8:11], s52 offen lds
    v_add_u32 v51, 8704, v51
    v_mul_u32_u24 v53, 36, v54
    v_lshl_add_u32 v53, v55, 4, v53
    v_add_u32 v53, s59, v53
    s_add_u32 s53, s73, 6
    s_and_b32 s53, s53, 15
    s_mul_i32 s53, s53, 88064
    s_add_u32 m0, s50, 0
    s_nop 0
    buffer_load_dwordx4 v152, s[12:15], s53 offen lds
    s_waitcnt lgkmcnt(0)
    s_lshl_b32 s58, s57, 16
    s_and_b32 s57, s57, 0xffff0000
    s_cmp_lt_u32 s54, 2
    s_cselect_b32 s57, s58, s57
    s_add_u32 m0, s50, 1024
    s_nop 0
    buffer_load_dwordx4 v153, s[12:15], s53 offen lds
    v_mov_b32 v14, 0x3fb8aa3b
    v_mul_f32 v14, s57, v14
    v_exp_f32 v14, v14
    s_nop 0
    v_cvt_pk_bf16_f32 v14, v14, v14
    s_add_u32 m0, s50, 2048
    s_nop 0
    buffer_load_dwordx4 v154, s[12:15], s53 offen lds
    v_and_b32 v14, 0xffff0000, v14
    v_lshlrev_b32 v2, 16, v2
    v_lshlrev_b32 v3, 16, v3
    v_lshlrev_b32 v4, 16, v4
    s_add_u32 s53, s73, 7
    s_and_b32 s53, s53, 15
    s_mul_i32 s53, s53, 88064
    s_add_u32 m0, s50, 12320
    s_nop 0
    buffer_load_dwordx4 v152, s[12:15], s53 offen lds
    v_lshlrev_b32 v5, 16, v5
    v_lshlrev_b32 v6, 16, v6
    v_lshlrev_b32 v7, 16, v7
    v_mul_f32 v16, v14, v2
    s_add_u32 m0, s50, 13344
    s_nop 0
    buffer_load_dwordx4 v153, s[12:15], s53 offen lds
    v_mul_f32 v17, v14, v3
    v_mul_f32 v16, 0x3fb8aa3b, v16
    v_mul_f32 v17, 0.15915494, v17
    v_mul_f32 v18, v14, v4
    s_add_u32 m0, s50, 14368
    s_nop 0
    buffer_load_dwordx4 v154, s[12:15], s53 offen lds
    v_mul_f32 v19, v14, v5
    v_pk_mul_f32 v[34:35], v[6:7], v[18:19] op_sel_hi:[0,1]
    v_pk_fma_f32 v[34:35], v[6:7], v[18:19], v[34:35] op_sel:[1,1,0] op_sel_hi:[1,0,1] neg_lo:[1,0,0]
    s_waitcnt vmcnt(10)
    s_barrier
    s_add_u32 s52, s99, 4
    s_and_b32 s52, s52, 7
    s_lshl_b32 s52, s52, 7
    s_add_u32 m0, s51, 16384
    s_nop 0
    buffer_load_dwordx4 v155, s[8:11], s52 offen lds
    v_mul_f32 v20, 0x3f800000, v16
    v_mul_f32 v21, 0x3f800000, v17
    v_exp_f32 v20, v20
    v_fract_f32 v21, v21
    s_add_u32 m0, s51, 17408
    s_nop 0
    buffer_load_dwordx4 v156, s[8:11], s52 offen lds
    v_cos_f32 v22, v21
    v_sin_f32 v23, v21
    s_nop 0
    v_mul_f32 v24, v20, v22
    s_add_u32 m0, s51, 18432
    s_nop 0
    buffer_load_dwordx4 v157, s[8:11], s52 offen lds
    v_mul_f32 v25, v20, v23
    v_mul_f32 v20, 0x41000000, v16
    v_mul_f32 v21, 0x41000000, v17
    v_exp_f32 v20, v20
    s_add_u32 m0, s51, 19456
    s_nop 0
    buffer_load_dwordx4 v158, s[8:11], s52 offen lds
    v_fract_f32 v21, v21
    v_cos_f32 v22, v21
    v_sin_f32 v23, v21
    s_nop 0
    s_add_u32 s53, s73, 8
    s_and_b32 s53, s53, 15
    s_mul_i32 s53, s53, 88064
    s_add_u32 m0, s50, 24640
    s_nop 0
    buffer_load_dwordx4 v152, s[12:15], s53 offen lds
    v_mul_f32 v26, v20, v22
    v_mul_f32 v27, v20, v23
    v_mul_f32 v20, 0x43800000, v16
    v_mul_f32 v21, 0x43800000, v17
    s_add_u32 m0, s50, 25664
    s_nop 0
    buffer_load_dwordx4 v153, s[12:15], s53 offen lds
    v_exp_f32 v20, v20
    v_fract_f32 v21, v21
    v_cos_f32 v22, v21
    v_sin_f32 v23, v21
    s_add_u32 m0, s50, 26688
    s_nop 0
    buffer_load_dwordx4 v154, s[12:15], s53 offen lds
    s_nop 0
    v_mul_f32 v28, v20, v22
    v_mul_f32 v29, v20, v23
    v_mov_b32 v64, 0x3f80
    s_add_u32 s53, s73, 9
    s_and_b32 s53, s53, 15
    s_mul_i32 s53, s53, 88064
    s_add_u32 m0, s50, 36960
    s_nop 0
    buffer_load_dwordx4 v152, s[12:15], s53 offen lds
    v_cvt_pk_bf16_f32 v65, v26, v27
    v_cvt_pk_bf16_f32 v96, v34, -v35
    v_pk_mul_f32 v[30:31], v[26:27], v[26:27] op_sel_hi:[0,1]
    v_pk_fma_f32 v[30:31], v[26:27], v[26:27], v[30:31] op_sel:[1,1,0] op_sel_hi:[1,0,1] neg_lo:[1,0,0]
    s_add_u32 m0, s50, 37984
    s_nop 0
    buffer_load_dwordx4 v153, s[12:15], s53 offen lds
    v_cvt_pk_bf16_f32 v66, v30, v31
    v_pk_mul_f32 v[36:37], v[34:35], v[24:25] op_sel_hi:[0,1]
    v_pk_fma_f32 v[36:37], v[34:35], v[24:25], v[36:37] op_sel:[1,1,0] op_sel_hi:[1,0,1] neg_lo:[1,0,0]
    v_cvt_pk_bf16_f32 v97, v36, -v37
    s_add_u32 m0, s50, 39008
    s_nop 0
    buffer_load_dwordx4 v154, s[12:15], s53 offen lds
    v_pk_mul_f32 v[32:33], v[30:31], v[26:27] op_sel_hi:[0,1]
    v_pk_fma_f32 v[32:33], v[30:31], v[26:27], v[32:33] op_sel:[1,1,0] op_sel_hi:[1,0,1] neg_lo:[1,0,0]
    v_cvt_pk_bf16_f32 v67, v32, v33
    v_pk_mul_f32 v[38:39], v[36:37], v[24:25] op_sel_hi:[0,1]
    s_waitcnt vmcnt(10)
    s_barrier
    s_add_u32 s52, s99, 5
    s_and_b32 s52, s52, 7
    s_lshl_b32 s52, s52, 7
    s_add_u32 m0, s51, 32768
    s_nop 0
    buffer_load_dwordx4 v155, s[8:11], s52 offen lds
    v_pk_fma_f32 v[38:39], v[36:37], v[24:25], v[38:39] op_sel:[1,1,0] op_sel_hi:[1,0,1] neg_lo:[1,0,0]
    v_cvt_pk_bf16_f32 v98, v38, -v39
    v_pk_mul_f32 v[30:31], v[32:33], v[26:27] op_sel_hi:[0,1]
    v_pk_fma_f32 v[30:31], v[32:33], v[26:27], v[30:31] op_sel:[1,1,0] op_sel_hi:[1,0,1] neg_lo:[1,0,0]
    s_add_u32 m0, s51, 33792
    s_nop 0
    buffer_load_dwordx4 v156, s[8:11], s52 offen lds
    v_cvt_pk_bf16_f32 v68, v30, v31
    v_pk_mul_f32 v[40:41], v[38:39], v[24:25] op_sel_hi:[0,1]
    v_pk_fma_f32 v[40:41], v[38:39], v[24:25], v[40:41] op_sel:[1,1,0] op_sel_hi:[1,0,1] neg_lo:[1,0,0]
    v_cvt_pk_bf16_f32 v99, v40, -v41
    s_add_u32 m0, s51, 34816
    s_nop 0
    buffer_load_dwordx4 v157, s[8:11], s52 offen lds
    v_pk_mul_f32 v[32:33], v[30:31], v[26:27] op_sel_hi:[0,1]
    v_pk_fma_f32 v[32:33], v[30:31], v[26:27], v[32:33] op_sel:[1,1,0] op_sel_hi:[1,0,1] neg_lo:[1,0,0]
    v_cvt_pk_bf16_f32 v69, v32, v33
    v_pk_mul_f32 v[42:43], v[40:41], v[24:25] op_sel_hi:[0,1]
    s_add_u32 m0, s51, 35840
    s_nop 0
    buffer_load_dwordx4 v158, s[8:11], s52 offen lds
    v_pk_fma_f32 v[42:43], v[40:41], v[24:25], v[42:43] op_sel:[1,1,0] op_sel_hi:[1,0,1] neg_lo:[1,0,0]
    v_cvt_pk_bf16_f32 v100, v42, -v43
    v_pk_mul_f32 v[30:31], v[32:33], v[26:27] op_sel_hi:[0,1]
    v_pk_fma_f32 v[30:31], v[32:33], v[26:27], v[30:31] op_sel:[1,1,0] op_sel_hi:[1,0,1] neg_lo:[1,0,0]
    s_add_u32 s53, s73, 10
    s_and_b32 s53, s53, 15
    s_mul_i32 s53, s53, 88064
    s_add_u32 m0, s50, 49280
    s_nop 0
    buffer_load_dwordx4 v152, s[12:15], s53 offen lds
    v_cvt_pk_bf16_f32 v70, v30, v31
    v_pk_mul_f32 v[44:45], v[42:43], v[24:25] op_sel_hi:[0,1]
    v_pk_fma_f32 v[44:45], v[42:43], v[24:25], v[44:45] op_sel:[1,1,0] op_sel_hi:[1,0,1] neg_lo:[1,0,0]
    v_cvt_pk_bf16_f32 v101, v44, -v45
    s_add_u32 m0, s50, 50304
    s_nop 0
    buffer_load_dwordx4 v153, s[12:15], s53 offen lds
    v_pk_mul_f32 v[32:33], v[30:31], v[26:27] op_sel_hi:[0,1]
    v_pk_fma_f32 v[32:33], v[30:31], v[26:27], v[32:33] op_sel:[1,1,0] op_sel_hi:[1,0,1] neg_lo:[1,0,0]
    v_cvt_pk_bf16_f32 v71, v32, v33
    v_pk_mul_f32 v[46:47], v[44:45], v[24:25] op_sel_hi:[0,1]
    s_add_u32 m0, s50, 51328
    s_nop 0
    buffer_load_dwordx4 v154, s[12:15], s53 offen lds
    v_pk_fma_f32 v[46:47], v[44:45], v[24:25], v[46:47] op_sel:[1,1,0] op_sel_hi:[1,0,1] neg_lo:[1,0,0]
    v_cvt_pk_bf16_f32 v102, v46, -v47
    v_pk_mul_f32 v[30:31], v[32:33], v[26:27] op_sel_hi:[0,1]
    v_pk_fma_f32 v[30:31], v[32:33], v[26:27], v[30:31] op_sel:[1,1,0] op_sel_hi:[1,0,1] neg_lo:[1,0,0]
    s_add_u32 s53, s73, 11
    s_and_b32 s53, s53, 15
    s_mul_i32 s53, s53, 88064
    s_add_u32 m0, s50, 61600
    s_nop 0
    buffer_load_dwordx4 v152, s[12:15], s53 offen lds
    v_cvt_pk_bf16_f32 v72, v30, v31
    v_pk_mul_f32 v[48:49], v[46:47], v[24:25] op_sel_hi:[0,1]
    v_pk_fma_f32 v[48:49], v[46:47], v[24:25], v[48:49] op_sel:[1,1,0] op_sel_hi:[1,0,1] neg_lo:[1,0,0]
    v_cvt_pk_bf16_f32 v103, v48, -v49
    s_add_u32 m0, s50, 62624
    s_nop 0
    buffer_load_dwordx4 v153, s[12:15], s53 offen lds
    v_pk_mul_f32 v[32:33], v[30:31], v[26:27] op_sel_hi:[0,1]
    v_pk_fma_f32 v[32:33], v[30:31], v[26:27], v[32:33] op_sel:[1,1,0] op_sel_hi:[1,0,1] neg_lo:[1,0,0]
    v_cvt_pk_bf16_f32 v73, v32, v33
    v_pk_mul_f32 v[56:57], v[38:39], v[28:29] op_sel_hi:[0,1]
    s_add_u32 m0, s50, 63648
    s_nop 0
    buffer_load_dwordx4 v154, s[12:15], s53 offen lds
    v_pk_fma_f32 v[56:57], v[38:39], v[28:29], v[56:57] op_sel:[1,1,0] op_sel_hi:[1,0,1] neg_lo:[1,0,0]
    v_cvt_pk_bf16_f32 v105, v56, -v57
    v_pk_mul_f32 v[30:31], v[32:33], v[26:27] op_sel_hi:[0,1]
    v_pk_fma_f32 v[30:31], v[32:33], v[26:27], v[30:31] op_sel:[1,1,0] op_sel_hi:[1,0,1] neg_lo:[1,0,0]
    s_waitcnt vmcnt(10)
    s_barrier
    s_add_u32 s52, s99, 6
    s_and_b32 s52, s52, 7
    s_lshl_b32 s52, s52, 7
    s_add_u32 m0, s51, 0
    s_nop 0
    buffer_load_dwordx4 v155, s[8:11], s52 offen lds
    v_cvt_pk_bf16_f32 v74, v30, v31
    v_pk_mul_f32 v[58:59], v[46:47], v[28:29] op_sel_hi:[0,1]
    v_pk_fma_f32 v[58:59], v[46:47], v[28:29], v[58:59] op_sel:[1,1,0] op_sel_hi:[1,0,1] neg_lo:[1,0,0]
    v_cvt_pk_bf16_f32 v109, v58, -v59
    s_add_u32 m0, s51, 1024
    s_nop 0
    buffer_load_dwordx4 v156, s[8:11], s52 offen lds
    v_pk_mul_f32 v[32:33], v[30:31], v[26:27] op_sel_hi:[0,1]
    v_pk_fma_f32 v[32:33], v[30:31], v[26:27], v[32:33] op_sel:[1,1,0] op_sel_hi:[1,0,1] neg_lo:[1,0,0]
    v_cvt_pk_bf16_f32 v75, v32, v33
    v_pk_mul_f32 v[56:57], v[42:43], v[28:29] op_sel_hi:[0,1]
    s_add_u32 m0, s51, 2048
    s_nop 0
    buffer_load_dwordx4 v157, s[8:11], s52 offen lds
    v_pk_fma_f32 v[56:57], v[42:43], v[28:29], v[56:57] op_sel:[1,1,0] op_sel_hi:[1,0,1] neg_lo:[1,0,0]
    v_cvt_pk_bf16_f32 v108, v56, -v57
    v_pk_mul_f32 v[30:31], v[32:33], v[26:27] op_sel_hi:[0,1]
    v_pk_fma_f32 v[30:31], v[32:33], v[26:27], v[30:31] op_sel:[1,1,0] op_sel_hi:[1,0,1] neg_lo:[1,0,0]
    s_add_u32 m0, s51, 3072
    s_nop 0
    buffer_load_dwordx4 v158, s[8:11], s52 offen lds
    v_cvt_pk_bf16_f32 v76, v30, v31
    v_pk_mul_f32 v[58:59], v[56:57], v[28:29] op_sel_hi:[0,1]
    v_pk_fma_f32 v[58:59], v[56:57], v[28:29], v[58:59] op_sel:[1,1,0] op_sel_hi:[1,0,1] neg_lo:[1,0,0]
    v_cvt_pk_bf16_f32 v110, v58, -v59
    s_add_u32 s53, s73, 12
    s_and_b32 s53, s53, 15
    s_mul_i32 s53, s53, 88064
    s_add_u32 m0, s50, 0
    s_nop 0
    buffer_load_dwordx4 v152, s[12:15], s53 offen lds
    v_pk_mul_f32 v[32:33], v[30:31], v[26:27] op_sel_hi:[0,1]
    v_pk_fma_f32 v[32:33], v[30:31], v[26:27], v[32:33] op_sel:[1,1,0] op_sel_hi:[1,0,1] neg_lo:[1,0,0]
    v_cvt_pk_bf16_f32 v77, v32, v33
    v_pk_mul_f32 v[56:57], v[58:59], v[28:29] op_sel_hi:[0,1]
    s_add_u32 m0, s50, 1024
    s_nop 0
    buffer_load_dwordx4 v153, s[12:15], s53 offen lds
    v_pk_fma_f32 v[56:57], v[58:59], v[28:29], v[56:57] op_sel:[1,1,0] op_sel_hi:[1,0,1] neg_lo:[1,0,0]
    v_cvt_pk_bf16_f32 v111, v56, -v57
    v_pk_mul_f32 v[30:31], v[32:33], v[26:27] op_sel_hi:[0,1]
    v_pk_fma_f32 v[30:31], v[32:33], v[26:27], v[30:31] op_sel:[1,1,0] op_sel_hi:[1,0,1] neg_lo:[1,0,0]
    s_add_u32 m0, s50, 2048
    s_nop 0
    buffer_load_dwordx4 v154, s[12:15], s53 offen lds
    v_cvt_pk_bf16_f32 v78, v30, v31
    v_pk_mul_f32 v[60:61], v[34:35], v[28:29] op_sel_hi:[0,1]
    v_pk_fma_f32 v[60:61], v[34:35], v[28:29], v[60:61] op_sel:[1,1,0] op_sel_hi:[1,0,1] neg_lo:[1,0,0]
    v_cvt_pk_bf16_f32 v104, v60, -v61
    s_add_u32 s53, s73, 13
    s_and_b32 s53, s53, 15
    s_mul_i32 s53, s53, 88064
    s_add_u32 m0, s50, 12320
    s_nop 0
    buffer_load_dwordx4 v152, s[12:15], s53 offen lds
    v_pk_mul_f32 v[32:33], v[30:31], v[26:27] op_sel_hi:[0,1]
    v_pk_fma_f32 v[32:33], v[30:31], v[26:27], v[32:33] op_sel:[1,1,0] op_sel_hi:[1,0,1] neg_lo:[1,0,0]
    v_cvt_pk_bf16_f32 v79, v32, v33
    v_pk_mul_f32 v[62:63], v[60:61], v[28:29] op_sel_hi:[0,1]
    s_add_u32 m0, s50, 13344
    s_nop 0
    buffer_load_dwordx4 v153, s[12:15], s53 offen lds
    v_pk_fma_f32 v[62:63], v[60:61], v[28:29], v[62:63] op_sel:[1,1,0] op_sel_hi:[1,0,1] neg_lo:[1,0,0]
    v_cvt_pk_bf16_f32 v106, v62, -v63
    v_pk_mul_f32 v[30:31], v[32:33], v[26:27] op_sel_hi:[0,1]
    v_pk_fma_f32 v[30:31], v[32:33], v[26:27], v[30:31] op_sel:[1,1,0] op_sel_hi:[1,0,1] neg_lo:[1,0,0]
    s_add_u32 m0, s50, 14368
    s_nop 0
    buffer_load_dwordx4 v154, s[12:15], s53 offen lds
    v_cvt_pk_bf16_f32 v80, v30, v31
    v_pk_mul_f32 v[60:61], v[62:63], v[28:29] op_sel_hi:[0,1]
    v_pk_fma_f32 v[60:61], v[62:63], v[28:29], v[60:61] op_sel:[1,1,0] op_sel_hi:[1,0,1] neg_lo:[1,0,0]
    v_cvt_pk_bf16_f32 v107, v60, -v61
    s_waitcnt vmcnt(10)
    s_barrier
    s_add_u32 s52, s99, 7
    s_and_b32 s52, s52, 7
    s_lshl_b32 s52, s52, 7
    s_add_u32 m0, s51, 16384
    s_nop 0
    buffer_load_dwordx4 v155, s[8:11], s52 offen lds
    v_pk_mul_f32 v[32:33], v[30:31], v[26:27] op_sel_hi:[0,1]
    v_pk_fma_f32 v[32:33], v[30:31], v[26:27], v[32:33] op_sel:[1,1,0] op_sel_hi:[1,0,1] neg_lo:[1,0,0]
    v_cvt_pk_bf16_f32 v81, v32, v33
    v_pk_mul_f32 v[62:63], v[60:61], v[28:29] op_sel_hi:[0,1]
    v_pk_fma_f32 v[62:63], v[60:61], v[28:29], v[62:63] op_sel:[1,1,0] op_sel_hi:[1,0,1] neg_lo:[1,0,0]
    v_cvt_pk_bf16_f32 v112, v62, -v63
    s_add_u32 m0, s51, 17408
    s_nop 0
    buffer_load_dwordx4 v156, s[8:11], s52 offen lds
    v_pk_mul_f32 v[30:31], v[32:33], v[26:27] op_sel_hi:[0,1]
    v_pk_fma_f32 v[30:31], v[32:33], v[26:27], v[30:31] op_sel:[1,1,0] op_sel_hi:[1,0,1] neg_lo:[1,0,0]
    v_cvt_pk_bf16_f32 v82, v30, v31
    v_pk_mul_f32 v[60:61], v[62:63], v[28:29] op_sel_hi:[0,1]
    v_pk_fma_f32 v[60:61], v[62:63], v[28:29], v[60:61] op_sel:[1,1,0] op_sel_hi:[1,0,1] neg_lo:[1,0,0]
    v_cvt_pk_bf16_f32 v113, v60, -v61
    s_add_u32 m0, s51, 18432
    s_nop 0
    buffer_load_dwordx4 v157, s[8:11], s52 offen lds
    v_pk_mul_f32 v[32:33], v[30:31], v[26:27] op_sel_hi:[0,1]
    v_pk_fma_f32 v[32:33], v[30:31], v[26:27], v[32:33] op_sel:[1,1,0] op_sel_hi:[1,0,1] neg_lo:[1,0,0]
    v_cvt_pk_bf16_f32 v83, v32, v33
    v_pk_mul_f32 v[62:63], v[60:61], v[28:29] op_sel_hi:[0,1]
    v_pk_fma_f32 v[62:63], v[60:61], v[28:29], v[62:63] op_sel:[1,1,0] op_sel_hi:[1,0,1] neg_lo:[1,0,0]
    v_cvt_pk_bf16_f32 v114, v62, -v63
    s_add_u32 m0, s51, 19456
    s_nop 0
    buffer_load_dwordx4 v158, s[8:11], s52 offen lds
    v_pk_mul_f32 v[30:31], v[32:33], v[26:27] op_sel_hi:[0,1]
    v_pk_fma_f32 v[30:31], v[32:33], v[26:27], v[30:31] op_sel:[1,1,0] op_sel_hi:[1,0,1] neg_lo:[1,0,0]
    v_cvt_pk_bf16_f32 v84, v30, v31
    v_pk_mul_f32 v[60:61], v[62:63], v[28:29] op_sel_hi:[0,1]
    v_pk_fma_f32 v[60:61], v[62:63], v[28:29], v[60:61] op_sel:[1,1,0] op_sel_hi:[1,0,1] neg_lo:[1,0,0]
    v_cvt_pk_bf16_f32 v115, v60, -v61
    s_add_u32 s53, s73, 14
    s_and_b32 s53, s53, 15
    s_mul_i32 s53, s53, 88064
    s_add_u32 m0, s50, 24640
    s_nop 0
    buffer_load_dwordx4 v152, s[12:15], s53 offen lds
    v_pk_mul_f32 v[32:33], v[30:31], v[26:27] op_sel_hi:[0,1]
    v_pk_fma_f32 v[32:33], v[30:31], v[26:27], v[32:33] op_sel:[1,1,0] op_sel_hi:[1,0,1] neg_lo:[1,0,0]
    v_cvt_pk_bf16_f32 v85, v32, v33
    v_pk_mul_f32 v[62:63], v[60:61], v[28:29] op_sel_hi:[0,1]
    v_pk_fma_f32 v[62:63], v[60:61], v[28:29], v[62:63] op_sel:[1,1,0] op_sel_hi:[1,0,1] neg_lo:[1,0,0]
    v_cvt_pk_bf16_f32 v116, v62, -v63
    s_add_u32 m0, s50, 25664
    s_nop 0
    buffer_load_dwordx4 v153, s[12:15], s53 offen lds
    v_pk_mul_f32 v[30:31], v[32:33], v[26:27] op_sel_hi:[0,1]
    v_pk_fma_f32 v[30:31], v[32:33], v[26:27], v[30:31] op_sel:[1,1,0] op_sel_hi:[1,0,1] neg_lo:[1,0,0]
    v_cvt_pk_bf16_f32 v86, v30, v31
    v_pk_mul_f32 v[32:33], v[30:31], v[26:27] op_sel_hi:[0,1]
    v_pk_fma_f32 v[32:33], v[30:31], v[26:27], v[32:33] op_sel:[1,1,0] op_sel_hi:[1,0,1] neg_lo:[1,0,0]
    v_cvt_pk_bf16_f32 v87, v32, v33
    s_add_u32 m0, s50, 26688
    s_nop 0
    buffer_load_dwordx4 v154, s[12:15], s53 offen lds
    v_pk_mul_f32 v[30:31], v[32:33], v[26:27] op_sel_hi:[0,1]
    v_pk_fma_f32 v[30:31], v[32:33], v[26:27], v[30:31] op_sel:[1,1,0] op_sel_hi:[1,0,1] neg_lo:[1,0,0]
    v_cvt_pk_bf16_f32 v88, v30, v31
    v_pk_mul_f32 v[32:33], v[30:31], v[26:27] op_sel_hi:[0,1]
    v_pk_fma_f32 v[32:33], v[30:31], v[26:27], v[32:33] op_sel:[1,1,0] op_sel_hi:[1,0,1] neg_lo:[1,0,0]
    v_cvt_pk_bf16_f32 v89, v32, v33
    s_add_u32 s53, s73, 15
    s_and_b32 s53, s53, 15
    s_mul_i32 s53, s53, 88064
    s_add_u32 m0, s50, 36960
    s_nop 0
    buffer_load_dwordx4 v152, s[12:15], s53 offen lds
    v_pk_mul_f32 v[30:31], v[32:33], v[26:27] op_sel_hi:[0,1]
    v_pk_fma_f32 v[30:31], v[32:33], v[26:27], v[30:31] op_sel:[1,1,0] op_sel_hi:[1,0,1] neg_lo:[1,0,0]
    v_cvt_pk_bf16_f32 v90, v30, v31
    v_pk_mul_f32 v[32:33], v[30:31], v[26:27] op_sel_hi:[0,1]
    v_pk_fma_f32 v[32:33], v[30:31], v[26:27], v[32:33] op_sel:[1,1,0] op_sel_hi:[1,0,1] neg_lo:[1,0,0]
    v_cvt_pk_bf16_f32 v91, v32, v33
    s_add_u32 m0, s50, 37984
    s_nop 0
    buffer_load_dwordx4 v153, s[12:15], s53 offen lds
    v_pk_mul_f32 v[30:31], v[32:33], v[26:27] op_sel_hi:[0,1]
    v_pk_fma_f32 v[30:31], v[32:33], v[26:27], v[30:31] op_sel:[1,1,0] op_sel_hi:[1,0,1] neg_lo:[1,0,0]
    v_cvt_pk_bf16_f32 v92, v30, v31
    v_pk_mul_f32 v[32:33], v[30:31], v[26:27] op_sel_hi:[0,1]
    v_pk_fma_f32 v[32:33], v[30:31], v[26:27], v[32:33] op_sel:[1,1,0] op_sel_hi:[1,0,1] neg_lo:[1,0,0]
    v_cvt_pk_bf16_f32 v93, v32, v33
    s_add_u32 m0, s50, 39008
    s_nop 0
    buffer_load_dwordx4 v154, s[12:15], s53 offen lds
    v_pk_mul_f32 v[30:31], v[32:33], v[26:27] op_sel_hi:[0,1]
    v_pk_fma_f32 v[30:31], v[32:33], v[26:27], v[30:31] op_sel:[1,1,0] op_sel_hi:[1,0,1] neg_lo:[1,0,0]
    v_cvt_pk_bf16_f32 v94, v30, v31
    v_pk_mul_f32 v[32:33], v[30:31], v[26:27] op_sel_hi:[0,1]
    v_pk_fma_f32 v[32:33], v[30:31], v[26:27], v[32:33] op_sel:[1,1,0] op_sel_hi:[1,0,1] neg_lo:[1,0,0]
    v_cvt_pk_bf16_f32 v95, v32, v33
L_tail:
    s_add_u32 s60, s48, 0x600000
    s_addc_u32 s61, s49, 0
    s_mov_b32 s62, 0x158000
    s_mov_b32 s63, 0x20000
    s_mov_b32 s70, s3
    s_mul_i32 s68, s70, 180224
    s_lshl_b32 s69, s71, 11
    s_add_u32 s68, s68, s69
    v_lshl_add_u32 v11, v0, 4, s68
    s_and_b32 s68, s5, 3
    s_mul_i32 s68, s68, 3
    s_add_u32 s68, s68, s71
    s_sub_u32 s69, s68, 11
    s_cmp_ge_u32 s68, 11
    s_cselect_b32 s68, s69, s68
    s_mov_b32 s68, 10
    s_lshl_b32 s96, s68, 14
    s_lshl_b32 s97, s68, 11
    s_lshl_b32 s68, s72, 1
    s_load_dword s98, s[32:33], s68
    s_add_u32 s64, s48, 0x1300000
    s_addc_u32 s65, s49, 0
    s_mov_b32 s66, 0x18000
    s_mov_b32 s67, 0x20000
    s_add_u32 s76, s48, 0x800000
    s_addc_u32 s77, s49, 0
    s_mov_b32 s78, 0x200000
    s_mov_b32 s79, 0x20000
    s_lshl_b32 s55, s54, 19
    s_lshl_b32 s56, s72, 5
    s_add_u32 s55, s55, s56
    v_lshrrev_b32 v12, 2, v0
    v_lshlrev_b32 v12, 14, v12
    v_and_b32 v13, 3, v0
    v_lshl_add_u32 v12, v13, 4, v12
    v_add_u32 v12, s55, v12
    v_add_u32 v13, 0x40000, v12
    s_waitcnt vmcnt(10)
    s_barrier
    ds_write_b32 v50, v64 offset:0
    ds_write_b32 v50, v65 offset:272
    ds_write_b32 v50, v66 offset:544
    ds_write_b32 v50, v67 offset:816
    ds_write_b32 v50, v68 offset:1088
    ds_write_b32 v50, v69 offset:1360
    ds_write_b32 v50, v70 offset:1632
    ds_write_b32 v50, v71 offset:1904
    ds_write_b32 v50, v72 offset:2176
    ds_write_b32 v50, v73 offset:2448
    ds_write_b32 v50, v74 offset:2720
    ds_write_b32 v50, v75 offset:2992
    ds_write_b32 v50, v76 offset:3264
    ds_write_b32 v50, v77 offset:3536
    ds_write_b32 v50, v78 offset:3808
    ds_write_b32 v50, v79 offset:4080
    ds_write_b32 v50, v80 offset:4352
    ds_write_b32 v50, v81 offset:4624
    ds_write_b32 v50, v82 offset:4896
    ds_write_b32 v50, v83 offset:5168
    ds_write_b32 v50, v84 offset:5440
    ds_write_b32 v50, v85 offset:5712
    ds_write_b32 v50, v86 offset:5984
    ds_write_b32 v50, v87 offset:6256
    ds_write_b32 v50, v88 offset:6528
    ds_write_b32 v50, v89 offset:6800
    ds_write_b32 v50, v90 offset:7072
    ds_write_b32 v50, v91 offset:7344
    ds_write_b32 v50, v92 offset:7616
    ds_write_b32 v50, v93 offset:7888
    ds_write_b32 v50, v94 offset:8160
    ds_write_b32 v50, v95 offset:8432
    ds_write_b32 v50, v96 offset:8704
    ds_write_b32 v50, v97 offset:8976
    ds_write_b32 v50, v98 offset:9248
    ds_write_b32 v50, v99 offset:9520
    ds_write_b32 v50, v100 offset:9792
    ds_write_b32 v50, v101 offset:10064
    ds_write_b32 v50, v102 offset:10336
    ds_write_b32 v50, v103 offset:10608
    ds_write_b32 v50, v104 offset:10880
    ds_write_b32 v50, v105 offset:11152
    ds_write_b32 v50, v106 offset:11424
    ds_write_b32 v50, v107 offset:11696
    ds_write_b32 v50, v108 offset:11968
    ds_write_b32 v50, v109 offset:12240
    ds_write_b32 v50, v110 offset:12512
    ds_write_b32 v50, v111 offset:12784
    ds_write_b32 v50, v112 offset:13056
    ds_write_b32 v50, v113 offset:13328
    ds_write_b32 v50, v114 offset:13600
    ds_write_b32 v50, v115 offset:13872
    s_waitcnt vmcnt(0)
    s_barrier
    buffer_load_dwordx4 v[144:147], v12, s[76:79], 0 offen sc1
    buffer_load_dwordx4 v[148:151], v13, s[76:79], 0 offen sc1
    s_add_u32 s96, s96, 16384
    s_cmp_eq_u32 s96, 180224
    s_cselect_b32 s96, 0, s96
    v_add_u32 v15, s96, v11
    buffer_load_dwordx4 v[168:171], v15, s[60:63], 0 offen sc1
    buffer_load_dwordx4 v[172:175], v15, s[60:63], 0 offen offset:1024 sc1
    ds_write_b32 v50, v116 offset:14144
    s_mul_i32 s55, s54, 1280
    s_add_u32 s58, s55, 35328
    v_lshrrev_b32 v8, 3, v0
    v_mul_u32_u24 v8, 80, v8
    v_bfe_u32 v9, v0, 2, 1
    v_lshl_add_u32 v8, v9, 5, v8
    v_and_b32 v9, 1, v0
    v_lshl_add_u32 v8, v9, 4, v8
    v_bfe_u32 v9, v0, 1, 1
    v_mul_u32_u24 v9, 7680, v9
    v_add3_u32 v14, v8, v9, s58
    s_lshr_b32 s56, s54, 1
    s_mul_i32 s56, s56, 5120
    s_add_u32 s55, s55, s56
    s_add_u32 s55, s55, 32768
    v_lshl_add_u32 v8, v0, 4, s55
    v_mov_b32 v4, 0
    v_mov_b32 v5, 0
    v_mov_b32 v6, 0
    v_mov_b32 v7, 0
    ds_write_b128 v8, v[4:7]
    ds_write_b128 v8, v[4:7] offset:256
    s_waitcnt lgkmcnt(0)
    ds_read_b128 v[64:67], v51 offset:0
    ds_read_b128 v[68:71], v52 offset:0
    ds_read_b128 v[72:75], v51 offset:32
    ds_read_b128 v[76:79], v52 offset:32
    ds_read_b128 v[80:83], v51 offset:64
    ds_read_b128 v[84:87], v52 offset:64
    ds_read_b128 v[88:91], v51 offset:96
    ds_read_b128 v[92:95], v52 offset:96
    ds_read_b128 v[96:99], v51 offset:128
    ds_read_b128 v[100:103], v52 offset:128
    ds_read_b128 v[104:107], v51 offset:160
    ds_read_b128 v[108:111], v52 offset:160
    ds_read_b128 v[112:115], v51 offset:192
    ds_read_b128 v[116:119], v52 offset:192
    ds_read_b128 v[120:123], v51 offset:224
    ds_read_b128 v[124:127], v52 offset:224
    s_waitcnt lgkmcnt(14)
    v_mfma_f32_32x32x16_bf16 v[128:143], v[64:67], v[68:71], 0
    s_waitcnt lgkmcnt(12)
    v_mfma_f32_32x32x16_bf16 v[128:143], v[72:75], v[76:79], v[128:143]
    s_waitcnt lgkmcnt(10)
    v_mfma_f32_32x32x16_bf16 v[128:143], v[80:83], v[84:87], v[128:143]
    s_waitcnt lgkmcnt(8)
    v_mfma_f32_32x32x16_bf16 v[128:143], v[88:91], v[92:95], v[128:143]
    s_waitcnt lgkmcnt(6)
    v_mfma_f32_32x32x16_bf16 v[128:143], v[96:99], v[100:103], v[128:143]
    s_waitcnt lgkmcnt(4)
    v_mfma_f32_32x32x16_bf16 v[128:143], v[104:107], v[108:111], v[128:143]
    s_waitcnt lgkmcnt(2)
    v_mfma_f32_32x32x16_bf16 v[128:143], v[112:115], v[116:119], v[128:143]
    s_waitcnt lgkmcnt(0)
    v_mfma_f32_32x32x16_bf16 v[128:143], v[120:123], v[124:127], v[128:143]
    s_nop 7
    s_nop 3
    ds_write_b32 v53, v128 offset:0
    ds_write_b32 v53, v129 offset:4
    ds_write_b32 v53, v130 offset:8
    ds_write_b32 v53, v131 offset:12
    ds_write_b32 v53, v132 offset:1152
    ds_write_b32 v53, v133 offset:1160
    ds_write_b32 v53, v134 offset:2304
    ds_write_b32 v53, v135 offset:3456
    ds_write_b32 v53, v136 offset:4608
    ds_write_b32 v53, v137 offset:5760
    ds_write_b32 v53, v138 offset:6912
    ds_write_b32 v53, v139 offset:8064
    ds_write_b32 v53, v140 offset:9216
    s_lshr_b32 s9, s54, 1
    s_mul_i32 s9, s9, 16640
    s_add_u32 s9, s9, 49152
    s_and_b32 s8, s54, 1
    s_lshl_b32 s8, s8, 11
    s_add_u32 s8, s8, s9
    v_lshl_add_u32 v1, v0, 4, s8
    v_add_u32 v2, 8316, v1
    v_add_u32 v3, 12476, v1
    v_add_u32 v8, 1024, v2
    v_add_u32 v9, 1024, v3
    v_lshrrev_b32 v5, 4, v0
    v_mul_u32_u24 v5, 4160, v5
    v_and_b32 v6, 15, v0
    v_lshl_add_u32 v5, v6, 2, v5
    v_lshrrev_b32 v7, 5, v0
    v_lshlrev_b32 v7, 2, v7
    v_sub_u32 v5, v5, v7
    v_add_u32 v5, s9, v5
    v_cmp_eq_u32 vcc, 0, v251
    s_waitcnt lgkmcnt(0)
    s_barrier
    ds_read2st64_b32 v[64:65], v232 offset1:57
    ds_read2st64_b32 v[66:67], v233 offset1:57
    ds_read2st64_b32 v[68:69], v234 offset1:57
    ds_read2st64_b32 v[70:71], v235 offset1:57
    ds_read2st64_b32 v[72:73], v236 offset1:57
    ds_read2st64_b32 v[74:75], v237 offset1:57
    ds_read2st64_b32 v[76:77], v238 offset1:57
    ds_read2st64_b32 v[78:79], v239 offset1:57
    ds_read2st64_b32 v[80:81], v240 offset1:57
    ds_read2st64_b32 v[82:83], v242 offset1:57
    ds_read2st64_b32 v[84:85], v243 offset1:57
    ds_read2st64_b32 v[86:87], v244 offset1:57
    ds_read2st64_b32 v[88:89], v245 offset1:57
    ds_read2st64_b32 v[90:91], v246 offset1:57
    ds_read2st64_b32 v[92:93], v247 offset1:57
    ds_read2st64_b32 v[94:95], v248 offset1:57
    ds_read2st64_b32 v[96:97], v249 offset1:57
    ds_read2st64_b32 v[98:99], v250 offset1:57
    s_add_u32 s96, s96, 16384
    s_cmp_eq_u32 s96, 180224
    s_cselect_b32 s96, 0, s96
    v_add_u32 v15, s96, v11
    buffer_load_dwordx4 v[176:179], v15, s[60:63], 0 offen sc1
    buffer_load_dwordx4 v[180:183], v15, s[60:63], 0 offen offset:1024 sc1
    s_add_u32 s96, s96, 16384
    s_cmp_eq_u32 s96, 180224
    s_cselect_b32 s96, 0, s96
    v_add_u32 v15, s96, v11
    buffer_load_dwordx4 v[184:187], v15, s[60:63], 0 offen sc1
    buffer_load_dwordx4 v[188:191], v15, s[60:63], 0 offen offset:1024 sc1
    s_waitcnt lgkmcnt(9)
    v_add_f32 v16, v64, v65
    v_add_f32 v17, v66, v67
    v_add_f32 v18, v68, v69
    v_add_f32 v19, v70, v71
    v_add_f32 v20, v72, v73
    v_add_f32 v21, v74, v75
    v_add_f32 v22, v76, v77
    v_add_f32 v23, v78, v79
    v_add_f32 v24, v80, v81
    s_waitcnt lgkmcnt(0)
    v_add_f32 v26, v82, v83
    v_add_f32 v27, v84, v85
    v_add_f32 v28, v86, v87
    v_add_f32 v29, v88, v89
    v_add_f32 v30, v90, v91
    v_add_f32 v31, v92, v93
    v_add_f32 v32, v94, v95
    v_add_f32 v33, v96, v97
    v_add_f32 v34, v98, v99
    v_cndmask_b32 v34, v34, v4, vcc
    v_cvt_pk_bf16_f32 v104, v16, v17
    v_cvt_pk_bf16_f32 v105, v18, v19
    v_cvt_pk_bf16_f32 v106, v20, v21
    v_cvt_pk_bf16_f32 v107, v22, v23
    v_cvt_pk_bf16_f32 v108, v17, v18
    v_cvt_pk_bf16_f32 v109, v19, v20
    v_cvt_pk_bf16_f32 v110, v21, v22
    v_cvt_pk_bf16_f32 v111, v23, v24
    v_cvt_pk_bf16_f32 v112, v26, v27
    v_cvt_pk_bf16_f32 v113, v28, v29
    v_cvt_pk_bf16_f32 v114, v30, v31
    v_cvt_pk_bf16_f32 v115, v32, v33
    v_cvt_pk_bf16_f32 v116, v27, v28
    v_cvt_pk_bf16_f32 v117, v29, v30
    v_cvt_pk_bf16_f32 v118, v31, v32
    v_cvt_pk_bf16_f32 v119, v33, v34
    ds_write_b32 v5, v4 offset:4096
    ds_write_b128 v1, v[104:107] offset:0
    ds_write_b128 v1, v[108:111] offset:4160
    ds_write2_b32 v2, v104, v105 offset1:1
    ds_write2_b32 v2, v106, v107 offset0:2 offset1:3
    ds_write2_b32 v3, v108, v109 offset1:1
    ds_write2_b32 v3, v110, v111 offset0:2 offset1:3
    ds_write_b128 v1, v[112:115] offset:1024
    ds_write_b128 v1, v[116:119] offset:5184
    ds_write2_b32 v8, v112, v113 offset1:1
    ds_write2_b32 v8, v114, v115 offset0:2 offset1:3
    ds_write2_b32 v9, v116, v117 offset1:1
    ds_write2_b32 v9, v118, v119 offset0:2 offset1:3
    s_waitcnt vmcnt(6)
    ds_write_b128 v14, v[144:147]
    ds_write_b128 v14, v[148:151] offset:640
    s_add_u32 s96, s96, 16384
    s_cmp_eq_u32 s96, 180224
    s_cselect_b32 s96, 0, s96
    v_add_u32 v15, s96, v11
    buffer_load_dwordx4 v[192:195], v15, s[60:63], 0 offen sc1
    buffer_load_dwordx4 v[196:199], v15, s[60:63], 0 offen offset:1024 sc1
    s_branch K_b1
K_helper:
    s_lshl_b32 s56, s6, 3
    s_add_u32 s56, s56, s3
    s_lshl_b32 s55, s56, 14
    v_lshlrev_b32 v3, 4, v0
    v_add_u32 v11, s55, v3
    s_waitcnt lgkmcnt(0)
    s_add_u32 s64, s48, 0x1300000
    s_addc_u32 s65, s49, 0
    s_mov_b32 s66, 0x18000
    s_mov_b32 s67, 0x20000
    s_mov_b32 s76, s46
    s_mov_b32 s77, s47
    s_mov_b32 s78, 0x100
    s_mov_b32 s79, 0x20000
    s_cmp_eq_u32 s3, 0
    s_cbranch_scc0 H_nz
    v_lshrrev_b32 v1, 4, v0
    v_lshlrev_b32 v1, 15, v1
    v_and_b32 v2, 15, v0
    v_lshl_add_u32 v1, v2, 7, v1
    s_lshl_b32 s55, s6, 11
    v_add_u32 v1, s55, v1
    v_mov_b32 v4, 0
    v_mov_b32 v5, 0
    v_mov_b32 v6, 0
    v_mov_b32 v7, 0
    buffer_store_dwordx4 v[4:7], v1, s[64:67], 0 offen sc1
    buffer_store_dwordx4 v[4:7], v1, s[64:67], 0 offen offset:16 sc1
    v_lshl_add_u32 v8, v0, 6, s6
    v_mov_b32 v9, 1
    s_waitcnt vmcnt(0)
    buffer_store_byte v9, v8, s[76:79], 0 offen sc1
H_nz:
    s_cmp_lt_u32 s3, 4
    s_cbranch_scc0 H_ne
    s_mov_b32 s99, s56
    s_lshl_b32 s8, s5, 2
    s_add_u32 s8, s8, s3
    s_lshl_b32 s8, s8, 14
    s_lshl_b32 s9, s4, 7
    s_add_u32 s9, s9, s8
    v_lshrrev_b32 v20, 3, v0
    v_lshlrev_b32 v20, 10, v20
    v_and_b32 v21, 7, v0
    v_lshl_add_u32 v20, v21, 4, v20
    v_add_u32 v20, s9, v20
    v_add_u32 v21, 0x2000, v20
    s_lshl_b32 s9, s4, 11
    s_add_u32 s9, s9, s8
    v_lshl_add_u32 v22, v0, 4, s9
    s_waitcnt lgkmcnt(0)
    s_mov_b32 s56, s40
    s_mov_b32 s57, s41
    s_mov_b32 s58, 0x158000
    s_mov_b32 s59, 0x20000
    s_mov_b32 s52, s16
    s_mov_b32 s53, s17
    s_mov_b32 s54, 0x200000
    s_mov_b32 s55, 0x20000
    buffer_load_dwordx4 v[176:179], v20, s[56:59], 0 offen
    buffer_load_dwordx4 v[180:183], v21, s[56:59], 0 offen
    buffer_load_dwordx4 v[184:187], v20, s[52:55], 0 offen
    buffer_load_dwordx4 v[188:191], v21, s[52:55], 0 offen
    v_and_b32 v31, 31, v0
    v_lshlrev_b32 v31, 5, v31
    v_lshrrev_b32 v24, 5, v0
    v_lshl_add_u32 v31, v24, 4, v31
    v_add_u32 v31, s9, v31
    s_lshl_b32 s8, s3, 12
    s_add_u32 s8, s8, 131072
    v_lshl_add_u32 v23, v0, 4, s8
    v_bfe_u32 v25, v0, 2, 2
    v_lshlrev_b32 v25, 7, v25
    v_bfe_u32 v21, v0, 4, 1
    v_lshl_add_u32 v25, v21, 5, v25
    v_and_b32 v21, 3, v0
    v_lshl_add_u32 v25, v21, 3, v25
    v_add_u32 v25, s8, v25
    v_lshl_add_u32 v21, v24, 10, v25
    v_lshl_add_u32 v24, v24, 9, v25
    s_add_u32 s52, s48, 0x800000
    s_addc_u32 s53, s49, 0
    s_mov_b32 s54, 0x200000
    s_mov_b32 s55, 0x20000
    s_add_u32 s56, s48, 0x600000
    s_addc_u32 s57, s49, 0
    s_mov_b32 s58, 0x158000
    s_mov_b32 s59, 0x20000
    s_add_u32 s64, s48, 0x1300000
    s_addc_u32 s65, s49, 0
    s_mov_b32 s66, 0x18000
    s_mov_b32 s67, 0x20000
    s_lshl_b32 s68, s2, 7
    s_lshl_b32 s69, s3, 2
    s_add_u32 s68, s68, s69
    s_add_u32 s68, s68, 0
    v_lshl_add_u32 v26, v0, 20, s68
    v_mov_b32 v27, 1
    s_waitcnt vmcnt(0)
    ds_write_b128 v23, v[176:179] offset:0
    ds_write_b128 v23, v[180:183] offset:1024
    ds_write_b128 v23, v[184:187] offset:2048
    ds_write_b128 v23, v[188:191] offset:3072
    s_waitcnt lgkmcnt(0)
    ds_read_b64_tr_b16 v[176:177], v24 offset:0
    ds_read_b64_tr_b16 v[178:179], v24 offset:1024
    ds_read_b64_tr_b16 v[180:181], v24 offset:64
    ds_read_b64_tr_b16 v[182:183], v24 offset:1088
    ds_read_b64_tr_b16 v[184:185], v21 offset:2048
    ds_read_b64_tr_b16 v[186:187], v21 offset:2560
    ds_read_b64_tr_b16 v[188:189], v21 offset:2112
    ds_read_b64_tr_b16 v[190:191], v21 offset:2624
    s_waitcnt lgkmcnt(0)
    buffer_store_dwordx4 v[176:179], v22, s[56:59], 0 offen sc1
    buffer_store_dwordx4 v[180:183], v22, s[56:59], 0 offen offset:1024 sc1
    buffer_store_dwordx4 v[184:187], v31, s[52:55], 0 offen sc1
    buffer_store_dwordx4 v[188:191], v31, s[52:55], 0 offen offset:1024 sc1
    s_lshl_b32 s68, s72, 12
    s_lshl_b32 s69, s3, 10
    s_add_u32 s68, s68, s69
    s_add_u32 s68, s68, 0x1000000
    v_lshl_add_u32 v196, v0, 4, s68
    v_add_u32 v197, 0x1000, v196
    v_mov_b32 v192, -1
    v_mov_b32 v193, -1
    v_mov_b32 v194, -1
    v_mov_b32 v195, -1
    global_store_dwordx4 v196, v[192:195], s[48:49] sc1
    global_store_dwordx4 v197, v[192:195], s[48:49] sc1
    s_mov_b32 s56, s99
H_ne:
    s_mov_b32 s8, s16
    s_mov_b32 s9, s17
    s_mov_b32 s10, 0x200000
    s_mov_b32 s11, 0x20000
    s_lshl_b32 s68, s2, 7
    s_lshl_b32 s69, s3, 2
    s_add_u32 s68, s68, s69
    s_add_u32 s68, s68, 0
    s_cmp_lt_u32 s3, 4
    s_cselect_b32 s68, s68, 0x100000
    v_lshl_add_u32 v26, v0, 20, s68
    v_mov_b32 v27, 1
    s_cmp_eq_u32 s3, 0
    s_cbranch_scc1 H_w0
    global_load_dwordx4 v[12:15], v3, s[42:43]
    s_movk_i32 s59, 0
    buffer_load_dwordx4 v[48:51], v11, s[8:11], s59 offen offset:0
    buffer_load_dwordx4 v[52:55], v11, s[8:11], s59 offen offset:1024
    buffer_load_dwordx4 v[56:59], v11, s[8:11], s59 offen offset:2048
    buffer_load_dwordx4 v[60:63], v11, s[8:11], s59 offen offset:3072
    s_movk_i32 s59, 4096
    buffer_load_dwordx4 v[64:67], v11, s[8:11], s59 offen offset:0
    buffer_load_dwordx4 v[68:71], v11, s[8:11], s59 offen offset:1024
    buffer_load_dwordx4 v[72:75], v11, s[8:11], s59 offen offset:2048
    buffer_load_dwordx4 v[76:79], v11, s[8:11], s59 offen offset:3072
    s_movk_i32 s59, 8192
    buffer_load_dwordx4 v[80:83], v11, s[8:11], s59 offen offset:0
    buffer_load_dwordx4 v[84:87], v11, s[8:11], s59 offen offset:1024
    buffer_load_dwordx4 v[88:91], v11, s[8:11], s59 offen offset:2048
    buffer_load_dwordx4 v[92:95], v11, s[8:11], s59 offen offset:3072
    s_movk_i32 s59, 12288
    buffer_load_dwordx4 v[96:99], v11, s[8:11], s59 offen offset:0
    buffer_load_dwordx4 v[100:103], v11, s[8:11], s59 offen offset:1024
    buffer_load_dwordx4 v[104:107], v11, s[8:11], s59 offen offset:2048
    buffer_load_dwordx4 v[108:111], v11, s[8:11], s59 offen offset:3072
    s_waitcnt vmcnt(17)
    s_barrier
    buffer_store_dword v27, v26, s[64:67], 0 offen sc1
    s_branch H_j
H_w0:
    s_mov_b32 s76, s46
    s_mov_b32 s77, s47
    s_mov_b32 s78, 0x100
    s_mov_b32 s79, 0x20000
    s_and_b32 s68, s5, 3
    s_lshl_b32 s68, s68, 6
    s_cmp_eq_u32 s3, 0
    s_cselect_b32 s68, s68, 0x1000
    s_cselect_b32 s69, 0x01010101, 0
    v_and_b32 v4, 3, v0
    v_lshl_add_u32 v4, v4, 2, s68
    v_mov_b32 v6, s69
    buffer_load_dword v5, v4, s[76:79], 0 offen sc1
    s_mov_b32 s70, 0
    s_waitcnt vmcnt(0)
H_pz:
    v_and_b32 v5, v5, v6
    v_cmp_ne_u32 vcc, v5, v6
    s_nop 4
    s_cbranch_vccz H_pz_ok
    s_add_u32 s70, s70, 1
    s_cmp_lt_u32 s70, 0x40000
    s_cbranch_scc0 H_pz_ok
    s_sleep 1
    buffer_load_dword v5, v4, s[76:79], 0 offen sc1
    s_waitcnt vmcnt(0)
    s_branch H_pz
H_pz_ok:
    s_barrier
    buffer_store_dword v27, v26, s[64:67], 0 offen sc1
    global_load_dwordx4 v[12:15], v3, s[42:43]
    s_movk_i32 s59, 0
    buffer_load_dwordx4 v[48:51], v11, s[8:11], s59 offen offset:0
    buffer_load_dwordx4 v[52:55], v11, s[8:11], s59 offen offset:1024
    buffer_load_dwordx4 v[56:59], v11, s[8:11], s59 offen offset:2048
    buffer_load_dwordx4 v[60:63], v11, s[8:11], s59 offen offset:3072
    s_movk_i32 s59, 4096
    buffer_load_dwordx4 v[64:67], v11, s[8:11], s59 offen offset:0
    buffer_load_dwordx4 v[68:71], v11, s[8:11], s59 offen offset:1024
    buffer_load_dwordx4 v[72:75], v11, s[8:11], s59 offen offset:2048
    buffer_load_dwordx4 v[76:79], v11, s[8:11], s59 offen offset:3072
    s_movk_i32 s59, 8192
    buffer_load_dwordx4 v[80:83], v11, s[8:11], s59 offen offset:0
    buffer_load_dwordx4 v[84:87], v11, s[8:11], s59 offen offset:1024
    buffer_load_dwordx4 v[88:91], v11, s[8:11], s59 offen offset:2048
    buffer_load_dwordx4 v[92:95], v11, s[8:11], s59 offen offset:3072
    s_movk_i32 s59, 12288
    buffer_load_dwordx4 v[96:99], v11, s[8:11], s59 offen offset:0
    buffer_load_dwordx4 v[100:103], v11, s[8:11], s59 offen offset:1024
    buffer_load_dwordx4 v[104:107], v11, s[8:11], s59 offen offset:2048
    buffer_load_dwordx4 v[108:111], v11, s[8:11], s59 offen offset:3072
H_j:
    s_add_u32 s60, s48, 0xf00000
    s_addc_u32 s61, s49, 0
    s_mov_b32 s62, 0x2000
    s_mov_b32 s63, 0x20000
    s_waitcnt vmcnt(0)
    v_mov_b32 v16, 0
    v_mov_b32 v17, 0
    v_mov_b32 v18, 0
    v_mov_b32 v19, 0
    v_mov_b32 v20, 0
    v_mov_b32 v21, 0
    v_mov_b32 v22, 0
    v_mov_b32 v23, 0
    v_mov_b32 v24, 0
    v_mov_b32 v25, 0
    v_mov_b32 v26, 0
    v_mov_b32 v27, 0
    v_mov_b32 v28, 0
    v_mov_b32 v29, 0
    v_mov_b32 v30, 0
    v_mov_b32 v31, 0
    v_dot2c_f32_bf16 v16, v48, v12
    v_dot2c_f32_bf16 v17, v52, v12
    v_dot2c_f32_bf16 v18, v56, v12
    v_dot2c_f32_bf16 v19, v60, v12
    v_dot2c_f32_bf16 v20, v64, v12
    v_dot2c_f32_bf16 v21, v68, v12
    v_dot2c_f32_bf16 v22, v72, v12
    v_dot2c_f32_bf16 v23, v76, v12
    v_dot2c_f32_bf16 v24, v80, v12
    v_dot2c_f32_bf16 v25, v84, v12
    v_dot2c_f32_bf16 v26, v88, v12
    v_dot2c_f32_bf16 v27, v92, v12
    v_dot2c_f32_bf16 v28, v96, v12
    v_dot2c_f32_bf16 v29, v100, v12
    v_dot2c_f32_bf16 v30, v104, v12
    v_dot2c_f32_bf16 v31, v108, v12
    v_dot2c_f32_bf16 v16, v49, v13
    v_dot2c_f32_bf16 v17, v53, v13
    v_dot2c_f32_bf16 v18, v57, v13
    v_dot2c_f32_bf16 v19, v61, v13
    v_dot2c_f32_bf16 v20, v65, v13
    v_dot2c_f32_bf16 v21, v69, v13
    v_dot2c_f32_bf16 v22, v73, v13
    v_dot2c_f32_bf16 v23, v77, v13
    v_dot2c_f32_bf16 v24, v81, v13
    v_dot2c_f32_bf16 v25, v85, v13
    v_dot2c_f32_bf16 v26, v89, v13
    v_dot2c_f32_bf16 v27, v93, v13
    v_dot2c_f32_bf16 v28, v97, v13
    v_dot2c_f32_bf16 v29, v101, v13
    v_dot2c_f32_bf16 v30, v105, v13
    v_dot2c_f32_bf16 v31, v109, v13
    v_dot2c_f32_bf16 v16, v50, v14
    v_dot2c_f32_bf16 v17, v54, v14
    v_dot2c_f32_bf16 v18, v58, v14
    v_dot2c_f32_bf16 v19, v62, v14
    v_dot2c_f32_bf16 v20, v66, v14
    v_dot2c_f32_bf16 v21, v70, v14
    v_dot2c_f32_bf16 v22, v74, v14
    v_dot2c_f32_bf16 v23, v78, v14
    v_dot2c_f32_bf16 v24, v82, v14
    v_dot2c_f32_bf16 v25, v86, v14
    v_dot2c_f32_bf16 v26, v90, v14
    v_dot2c_f32_bf16 v27, v94, v14
    v_dot2c_f32_bf16 v28, v98, v14
    v_dot2c_f32_bf16 v29, v102, v14
    v_dot2c_f32_bf16 v30, v106, v14
    v_dot2c_f32_bf16 v31, v110, v14
    v_dot2c_f32_bf16 v16, v51, v15
    v_dot2c_f32_bf16 v17, v55, v15
    v_dot2c_f32_bf16 v18, v59, v15
    v_dot2c_f32_bf16 v19, v63, v15
    v_dot2c_f32_bf16 v20, v67, v15
    v_dot2c_f32_bf16 v21, v71, v15
    v_dot2c_f32_bf16 v22, v75, v15
    v_dot2c_f32_bf16 v23, v79, v15
    v_dot2c_f32_bf16 v24, v83, v15
    v_dot2c_f32_bf16 v25, v87, v15
    v_dot2c_f32_bf16 v26, v91, v15
    v_dot2c_f32_bf16 v27, v95, v15
    v_dot2c_f32_bf16 v28, v99, v15
    v_dot2c_f32_bf16 v29, v103, v15
    v_dot2c_f32_bf16 v30, v107, v15
    v_dot2c_f32_bf16 v31, v111, v15
    s_nop 3
    v_add_f32_dpp v16, v16, v16 row_shr:1 row_mask:0xf bank_mask:0xf bound_ctrl:0
    v_add_f32_dpp v17, v17, v17 row_shr:1 row_mask:0xf bank_mask:0xf bound_ctrl:0
    v_add_f32_dpp v18, v18, v18 row_shr:1 row_mask:0xf bank_mask:0xf bound_ctrl:0
    v_add_f32_dpp v19, v19, v19 row_shr:1 row_mask:0xf bank_mask:0xf bound_ctrl:0
    v_add_f32_dpp v20, v20, v20 row_shr:1 row_mask:0xf bank_mask:0xf bound_ctrl:0
    v_add_f32_dpp v21, v21, v21 row_shr:1 row_mask:0xf bank_mask:0xf bound_ctrl:0
    v_add_f32_dpp v22, v22, v22 row_shr:1 row_mask:0xf bank_mask:0xf bound_ctrl:0
    v_add_f32_dpp v23, v23, v23 row_shr:1 row_mask:0xf bank_mask:0xf bound_ctrl:0
    v_add_f32_dpp v24, v24, v24 row_shr:1 row_mask:0xf bank_mask:0xf bound_ctrl:0
    v_add_f32_dpp v25, v25, v25 row_shr:1 row_mask:0xf bank_mask:0xf bound_ctrl:0
    v_add_f32_dpp v26, v26, v26 row_shr:1 row_mask:0xf bank_mask:0xf bound_ctrl:0
    v_add_f32_dpp v27, v27, v27 row_shr:1 row_mask:0xf bank_mask:0xf bound_ctrl:0
    v_add_f32_dpp v28, v28, v28 row_shr:1 row_mask:0xf bank_mask:0xf bound_ctrl:0
    v_add_f32_dpp v29, v29, v29 row_shr:1 row_mask:0xf bank_mask:0xf bound_ctrl:0
    v_add_f32_dpp v30, v30, v30 row_shr:1 row_mask:0xf bank_mask:0xf bound_ctrl:0
    v_add_f32_dpp v31, v31, v31 row_shr:1 row_mask:0xf bank_mask:0xf bound_ctrl:0
    v_add_f32_dpp v16, v16, v16 row_shr:2 row_mask:0xf bank_mask:0xf bound_ctrl:0
    v_add_f32_dpp v17, v17, v17 row_shr:2 row_mask:0xf bank_mask:0xf bound_ctrl:0
    v_add_f32_dpp v18, v18, v18 row_shr:2 row_mask:0xf bank_mask:0xf bound_ctrl:0
    v_add_f32_dpp v19, v19, v19 row_shr:2 row_mask:0xf bank_mask:0xf bound_ctrl:0
    v_add_f32_dpp v20, v20, v20 row_shr:2 row_mask:0xf bank_mask:0xf bound_ctrl:0
    v_add_f32_dpp v21, v21, v21 row_shr:2 row_mask:0xf bank_mask:0xf bound_ctrl:0
    v_add_f32_dpp v22, v22, v22 row_shr:2 row_mask:0xf bank_mask:0xf bound_ctrl:0
    v_add_f32_dpp v23, v23, v23 row_shr:2 row_mask:0xf bank_mask:0xf bound_ctrl:0
    v_add_f32_dpp v24, v24, v24 row_shr:2 row_mask:0xf bank_mask:0xf bound_ctrl:0
    v_add_f32_dpp v25, v25, v25 row_shr:2 row_mask:0xf bank_mask:0xf bound_ctrl:0
    v_add_f32_dpp v26, v26, v26 row_shr:2 row_mask:0xf bank_mask:0xf bound_ctrl:0
    v_add_f32_dpp v27, v27, v27 row_shr:2 row_mask:0xf bank_mask:0xf bound_ctrl:0
    v_add_f32_dpp v28, v28, v28 row_shr:2 row_mask:0xf bank_mask:0xf bound_ctrl:0
    v_add_f32_dpp v29, v29, v29 row_shr:2 row_mask:0xf bank_mask:0xf bound_ctrl:0
    v_add_f32_dpp v30, v30, v30 row_shr:2 row_mask:0xf bank_mask:0xf bound_ctrl:0
    v_add_f32_dpp v31, v31, v31 row_shr:2 row_mask:0xf bank_mask:0xf bound_ctrl:0
    v_add_f32_dpp v16, v16, v16 row_shr:4 row_mask:0xf bank_mask:0xf bound_ctrl:0
    v_add_f32_dpp v17, v17, v17 row_shr:4 row_mask:0xf bank_mask:0xf bound_ctrl:0
    v_add_f32_dpp v18, v18, v18 row_shr:4 row_mask:0xf bank_mask:0xf bound_ctrl:0
    v_add_f32_dpp v19, v19, v19 row_shr:4 row_mask:0xf bank_mask:0xf bound_ctrl:0
    v_add_f32_dpp v20, v20, v20 row_shr:4 row_mask:0xf bank_mask:0xf bound_ctrl:0
    v_add_f32_dpp v21, v21, v21 row_shr:4 row_mask:0xf bank_mask:0xf bound_ctrl:0
    v_add_f32_dpp v22, v22, v22 row_shr:4 row_mask:0xf bank_mask:0xf bound_ctrl:0
    v_add_f32_dpp v23, v23, v23 row_shr:4 row_mask:0xf bank_mask:0xf bound_ctrl:0
    v_add_f32_dpp v24, v24, v24 row_shr:4 row_mask:0xf bank_mask:0xf bound_ctrl:0
    v_add_f32_dpp v25, v25, v25 row_shr:4 row_mask:0xf bank_mask:0xf bound_ctrl:0
    v_add_f32_dpp v26, v26, v26 row_shr:4 row_mask:0xf bank_mask:0xf bound_ctrl:0
    v_add_f32_dpp v27, v27, v27 row_shr:4 row_mask:0xf bank_mask:0xf bound_ctrl:0
    v_add_f32_dpp v28, v28, v28 row_shr:4 row_mask:0xf bank_mask:0xf bound_ctrl:0
    v_add_f32_dpp v29, v29, v29 row_shr:4 row_mask:0xf bank_mask:0xf bound_ctrl:0
    v_add_f32_dpp v30, v30, v30 row_shr:4 row_mask:0xf bank_mask:0xf bound_ctrl:0
    v_add_f32_dpp v31, v31, v31 row_shr:4 row_mask:0xf bank_mask:0xf bound_ctrl:0
    v_add_f32_dpp v16, v16, v16 row_shr:8 row_mask:0xf bank_mask:0xf bound_ctrl:0
    v_add_f32_dpp v17, v17, v17 row_shr:8 row_mask:0xf bank_mask:0xf bound_ctrl:0
    v_add_f32_dpp v18, v18, v18 row_shr:8 row_mask:0xf bank_mask:0xf bound_ctrl:0
    v_add_f32_dpp v19, v19, v19 row_shr:8 row_mask:0xf bank_mask:0xf bound_ctrl:0
    v_add_f32_dpp v20, v20, v20 row_shr:8 row_mask:0xf bank_mask:0xf bound_ctrl:0
    v_add_f32_dpp v21, v21, v21 row_shr:8 row_mask:0xf bank_mask:0xf bound_ctrl:0
    v_add_f32_dpp v22, v22, v22 row_shr:8 row_mask:0xf bank_mask:0xf bound_ctrl:0
    v_add_f32_dpp v23, v23, v23 row_shr:8 row_mask:0xf bank_mask:0xf bound_ctrl:0
    v_add_f32_dpp v24, v24, v24 row_shr:8 row_mask:0xf bank_mask:0xf bound_ctrl:0
    v_add_f32_dpp v25, v25, v25 row_shr:8 row_mask:0xf bank_mask:0xf bound_ctrl:0
    v_add_f32_dpp v26, v26, v26 row_shr:8 row_mask:0xf bank_mask:0xf bound_ctrl:0
    v_add_f32_dpp v27, v27, v27 row_shr:8 row_mask:0xf bank_mask:0xf bound_ctrl:0
    v_add_f32_dpp v28, v28, v28 row_shr:8 row_mask:0xf bank_mask:0xf bound_ctrl:0
    v_add_f32_dpp v29, v29, v29 row_shr:8 row_mask:0xf bank_mask:0xf bound_ctrl:0
    v_add_f32_dpp v30, v30, v30 row_shr:8 row_mask:0xf bank_mask:0xf bound_ctrl:0
    v_add_f32_dpp v31, v31, v31 row_shr:8 row_mask:0xf bank_mask:0xf bound_ctrl:0
    v_add_f32_dpp v16, v16, v16 row_bcast:15 row_mask:0xa bank_mask:0xf
    v_add_f32_dpp v17, v17, v17 row_bcast:15 row_mask:0xa bank_mask:0xf
    v_add_f32_dpp v18, v18, v18 row_bcast:15 row_mask:0xa bank_mask:0xf
    v_add_f32_dpp v19, v19, v19 row_bcast:15 row_mask:0xa bank_mask:0xf
    v_add_f32_dpp v20, v20, v20 row_bcast:15 row_mask:0xa bank_mask:0xf
    v_add_f32_dpp v21, v21, v21 row_bcast:15 row_mask:0xa bank_mask:0xf
    v_add_f32_dpp v22, v22, v22 row_bcast:15 row_mask:0xa bank_mask:0xf
    v_add_f32_dpp v23, v23, v23 row_bcast:15 row_mask:0xa bank_mask:0xf
    v_add_f32_dpp v24, v24, v24 row_bcast:15 row_mask:0xa bank_mask:0xf
    v_add_f32_dpp v25, v25, v25 row_bcast:15 row_mask:0xa bank_mask:0xf
    v_add_f32_dpp v26, v26, v26 row_bcast:15 row_mask:0xa bank_mask:0xf
    v_add_f32_dpp v27, v27, v27 row_bcast:15 row_mask:0xa bank_mask:0xf
    v_add_f32_dpp v28, v28, v28 row_bcast:15 row_mask:0xa bank_mask:0xf
    v_add_f32_dpp v29, v29, v29 row_bcast:15 row_mask:0xa bank_mask:0xf
    v_add_f32_dpp v30, v30, v30 row_bcast:15 row_mask:0xa bank_mask:0xf
    v_add_f32_dpp v31, v31, v31 row_bcast:15 row_mask:0xa bank_mask:0xf
    v_add_f32_dpp v16, v16, v16 row_bcast:31 row_mask:0xc bank_mask:0xf
    v_add_f32_dpp v17, v17, v17 row_bcast:31 row_mask:0xc bank_mask:0xf
    v_add_f32_dpp v18, v18, v18 row_bcast:31 row_mask:0xc bank_mask:0xf
    v_add_f32_dpp v19, v19, v19 row_bcast:31 row_mask:0xc bank_mask:0xf
    v_add_f32_dpp v20, v20, v20 row_bcast:31 row_mask:0xc bank_mask:0xf
    v_add_f32_dpp v21, v21, v21 row_bcast:31 row_mask:0xc bank_mask:0xf
    v_add_f32_dpp v22, v22, v22 row_bcast:31 row_mask:0xc bank_mask:0xf
    v_add_f32_dpp v23, v23, v23 row_bcast:31 row_mask:0xc bank_mask:0xf
    v_add_f32_dpp v24, v24, v24 row_bcast:31 row_mask:0xc bank_mask:0xf
    v_add_f32_dpp v25, v25, v25 row_bcast:31 row_mask:0xc bank_mask:0xf
    v_add_f32_dpp v26, v26, v26 row_bcast:31 row_mask:0xc bank_mask:0xf
    v_add_f32_dpp v27, v27, v27 row_bcast:31 row_mask:0xc bank_mask:0xf
    v_add_f32_dpp v28, v28, v28 row_bcast:31 row_mask:0xc bank_mask:0xf
    v_add_f32_dpp v29, v29, v29 row_bcast:31 row_mask:0xc bank_mask:0xf
    v_add_f32_dpp v30, v30, v30 row_bcast:31 row_mask:0xc bank_mask:0xf
    v_add_f32_dpp v31, v31, v31 row_bcast:31 row_mask:0xc bank_mask:0xf
    v_cvt_pk_bf16_f32 v32, v16, v17
    v_cvt_pk_bf16_f32 v34, v18, v19
    v_cvt_pk_bf16_f32 v36, v20, v21
    v_cvt_pk_bf16_f32 v38, v22, v23
    v_cvt_pk_bf16_f32 v40, v24, v25
    v_cvt_pk_bf16_f32 v42, v26, v27
    v_cvt_pk_bf16_f32 v44, v28, v29
    v_cvt_pk_bf16_f32 v46, v30, v31
    v_lshlrev_b32 v16, 16, v32
    v_and_b32 v17, 0xffff0000, v32
    v_lshlrev_b32 v18, 16, v34
    v_and_b32 v19, 0xffff0000, v34
    v_lshlrev_b32 v20, 16, v36
    v_and_b32 v21, 0xffff0000, v36
    v_lshlrev_b32 v22, 16, v38
    v_and_b32 v23, 0xffff0000, v38
    v_lshlrev_b32 v24, 16, v40
    v_and_b32 v25, 0xffff0000, v40
    v_lshlrev_b32 v26, 16, v42
    v_and_b32 v27, 0xffff0000, v42
    v_lshlrev_b32 v28, 16, v44
    v_and_b32 v29, 0xffff0000, v44
    v_lshlrev_b32 v30, 16, v46
    v_and_b32 v31, 0xffff0000, v46
    v_mul_f32 v16, 0xbfb8aa3b, v16
    v_mul_f32 v17, 0xbfb8aa3b, v17
    v_mul_f32 v18, 0xbfb8aa3b, v18
    v_mul_f32 v19, 0xbfb8aa3b, v19
    v_mul_f32 v20, 0xbfb8aa3b, v20
    v_mul_f32 v21, 0xbfb8aa3b, v21
    v_mul_f32 v22, 0xbfb8aa3b, v22
    v_mul_f32 v23, 0xbfb8aa3b, v23
    v_mul_f32 v24, 0xbfb8aa3b, v24
    v_mul_f32 v25, 0xbfb8aa3b, v25
    v_mul_f32 v26, 0xbfb8aa3b, v26
    v_mul_f32 v27, 0xbfb8aa3b, v27
    v_mul_f32 v28, 0xbfb8aa3b, v28
    v_mul_f32 v29, 0xbfb8aa3b, v29
    v_mul_f32 v30, 0xbfb8aa3b, v30
    v_mul_f32 v31, 0xbfb8aa3b, v31
    v_exp_f32 v16, v16
    v_exp_f32 v17, v17
    v_exp_f32 v18, v18
    v_exp_f32 v19, v19
    v_exp_f32 v20, v20
    v_exp_f32 v21, v21
    v_exp_f32 v22, v22
    v_exp_f32 v23, v23
    v_exp_f32 v24, v24
    v_exp_f32 v25, v25
    v_exp_f32 v26, v26
    v_exp_f32 v27, v27
    v_exp_f32 v28, v28
    v_exp_f32 v29, v29
    v_exp_f32 v30, v30
    v_exp_f32 v31, v31
    v_add_f32 v16, 1.0, v16
    v_add_f32 v17, 1.0, v17
    v_add_f32 v18, 1.0, v18
    v_add_f32 v19, 1.0, v19
    v_add_f32 v20, 1.0, v20
    v_add_f32 v21, 1.0, v21
    v_add_f32 v22, 1.0, v22
    v_add_f32 v23, 1.0, v23
    v_add_f32 v24, 1.0, v24
    v_add_f32 v25, 1.0, v25
    v_add_f32 v26, 1.0, v26
    v_add_f32 v27, 1.0, v27
    v_add_f32 v28, 1.0, v28
    v_add_f32 v29, 1.0, v29
    v_add_f32 v30, 1.0, v30
    v_add_f32 v31, 1.0, v31
    v_rcp_f32 v16, v16
    v_rcp_f32 v17, v17
    v_rcp_f32 v18, v18
    v_rcp_f32 v19, v19
    v_rcp_f32 v20, v20
    v_rcp_f32 v21, v21
    v_rcp_f32 v22, v22
    v_rcp_f32 v23, v23
    v_rcp_f32 v24, v24
    v_rcp_f32 v25, v25
    v_rcp_f32 v26, v26
    v_rcp_f32 v27, v27
    v_rcp_f32 v28, v28
    v_rcp_f32 v29, v29
    v_rcp_f32 v30, v30
    v_rcp_f32 v31, v31
    v_cvt_pk_bf16_f32 v32, v16, v17
    v_cvt_pk_bf16_f32 v34, v18, v19
    v_cvt_pk_bf16_f32 v36, v20, v21
    v_cvt_pk_bf16_f32 v38, v22, v23
    v_cvt_pk_bf16_f32 v40, v24, v25
    v_cvt_pk_bf16_f32 v42, v26, v27
    v_cvt_pk_bf16_f32 v44, v28, v29
    v_cvt_pk_bf16_f32 v46, v30, v31
    v_lshlrev_b32 v16, 16, v32
    v_and_b32 v17, 0xffff0000, v32
    v_lshlrev_b32 v18, 16, v34
    v_and_b32 v19, 0xffff0000, v34
    v_lshlrev_b32 v20, 16, v36
    v_and_b32 v21, 0xffff0000, v36
    v_lshlrev_b32 v22, 16, v38
    v_and_b32 v23, 0xffff0000, v38
    v_lshlrev_b32 v24, 16, v40
    v_and_b32 v25, 0xffff0000, v40
    v_lshlrev_b32 v26, 16, v42
    v_and_b32 v27, 0xffff0000, v42
    v_lshlrev_b32 v28, 16, v44
    v_and_b32 v29, 0xffff0000, v44
    v_lshlrev_b32 v30, 16, v46
    v_and_b32 v31, 0xffff0000, v46
    s_lshl_b32 s57, s56, 6
    v_mov_b32 v1, s57
    v_mov_b32 v2, 0x100000
    v_cmp_eq_u32 vcc, 63, v0
    s_nop 1
    v_cndmask_b32 v1, v2, v1, vcc
    buffer_store_dwordx4 v[16:19], v1, s[60:63], 0 offen offset:0 sc1
    buffer_store_dwordx4 v[20:23], v1, s[60:63], 0 offen offset:16 sc1
    buffer_store_dwordx4 v[24:27], v1, s[60:63], 0 offen offset:32 sc1
    buffer_store_dwordx4 v[28:31], v1, s[60:63], 0 offen offset:48 sc1
    s_waitcnt vmcnt(0)
    s_barrier
    s_cmp_lt_u32 s3, 4
    s_cbranch_scc1 H_g
    s_sub_u32 s54, s3, 4
    s_lshl_b32 s55, s72, 8
    s_lshl_b32 s56, s54, 7
    s_add_u32 s55, s55, s56
    v_lshl_add_u32 v1, v0, 1, s55
    s_lshl_b32 s55, s72, 1
    s_load_dword s57, s[30:31], s55
    global_load_ushort v2, v1, s[18:19]
    global_load_ushort v3, v1, s[20:21]
    global_load_ushort v4, v1, s[22:23]
    global_load_ushort v5, v1, s[24:25]
    global_load_ushort v6, v1, s[26:27]
    global_load_ushort v7, v1, s[28:29]
    s_waitcnt vmcnt(0)
    s_and_b32 s68, s54, 1
    s_lshl_b32 s68, s68, 10
    s_sub_u32 s68, 2040, s68
    s_lshr_b32 s69, s54, 1
    s_mul_i32 s69, s69, 29184
    s_add_u32 s69, s69, 98560
    v_lshlrev_b32 v56, 3, v0
    v_sub_u32 v241, s68, v56
    v_or_b32 v57, 1, v241
    v_cvt_f32_u32 v57, v57
    v_lshrrev_b32 v57, 23, v57
    v_subrev_u32 v57, 134, v57
    v_max_i32 v60, 0, v57
    v_lshlrev_b32 v58, v60, 4
    v_add_u32 v61, 150, v60
    v_lshlrev_b32 v61, 23, v61
    v_or_b32 v61, 0x400000, v61
    v_mul_u32_u24 v59, v61, v58
    v_sub_u32 v59, 0, v59
    v_cvt_f32_u32 v57, v241
    v_add_f32 v57, v57, v61
    v_subrev_u32 v62, 1, v241
    v_max_i32 v62, 0, v62
    v_cvt_f32_u32 v62, v62
    v_cvt_pk_bf16_f32 v62, v62, v62
    v_lshlrev_b32 v62, 16, v62
    v_cvt_u32_f32 v62, v62
    v_lshrrev_b32 v63, 3, v62
    v_add_u32 v62, v62, v63
    v_lshl_add_u32 v240, v62, 2, s69
    v_add_f32 v232, 0x40e00000, v57
    v_mad_u32_u24 v232, v232, v58, v59
    v_lshrrev_b32 v63, 5, v232
    v_lshl_add_u32 v63, v63, 2, s69
    v_add_u32 v232, v232, v63
    v_add_f32 v233, 0x40c00000, v57
    v_mad_u32_u24 v233, v233, v58, v59
    v_lshrrev_b32 v63, 5, v233
    v_lshl_add_u32 v63, v63, 2, s69
    v_add_u32 v233, v233, v63
    v_add_f32 v234, 0x40a00000, v57
    v_mad_u32_u24 v234, v234, v58, v59
    v_lshrrev_b32 v63, 5, v234
    v_lshl_add_u32 v63, v63, 2, s69
    v_add_u32 v234, v234, v63
    v_add_f32 v235, 0x40800000, v57
    v_mad_u32_u24 v235, v235, v58, v59
    v_lshrrev_b32 v63, 5, v235
    v_lshl_add_u32 v63, v63, 2, s69
    v_add_u32 v235, v235, v63
    v_add_f32 v236, 0x40400000, v57
    v_mad_u32_u24 v236, v236, v58, v59
    v_lshrrev_b32 v63, 5, v236
    v_lshl_add_u32 v63, v63, 2, s69
    v_add_u32 v236, v236, v63
    v_add_f32 v237, 0x40000000, v57
    v_mad_u32_u24 v237, v237, v58, v59
    v_lshrrev_b32 v63, 5, v237
    v_lshl_add_u32 v63, v63, 2, s69
    v_add_u32 v237, v237, v63
    v_add_f32 v238, 0x3f800000, v57
    v_mad_u32_u24 v238, v238, v58, v59
    v_lshrrev_b32 v63, 5, v238
    v_lshl_add_u32 v63, v63, 2, s69
    v_add_u32 v238, v238, v63
    v_add_f32 v239, 0x00000000, v57
    v_mad_u32_u24 v239, v239, v58, v59
    v_lshrrev_b32 v63, 5, v239
    v_lshl_add_u32 v63, v63, 2, s69
    v_add_u32 v239, v239, v63
    s_and_b32 s68, s54, 1
    s_lshl_b32 s68, s68, 10
    s_sub_u32 s68, 1528, s68
    s_lshr_b32 s69, s54, 1
    s_mul_i32 s69, s69, 29184
    s_add_u32 s69, s69, 98560
    v_lshlrev_b32 v56, 3, v0
    v_sub_u32 v251, s68, v56
    v_or_b32 v57, 1, v251
    v_cvt_f32_u32 v57, v57
    v_lshrrev_b32 v57, 23, v57
    v_subrev_u32 v57, 134, v57
    v_max_i32 v60, 0, v57
    v_lshlrev_b32 v58, v60, 4
    v_add_u32 v61, 150, v60
    v_lshlrev_b32 v61, 23, v61
    v_or_b32 v61, 0x400000, v61
    v_mul_u32_u24 v59, v61, v58
    v_sub_u32 v59, 0, v59
    v_cvt_f32_u32 v57, v251
    v_add_f32 v57, v57, v61
    v_subrev_u32 v62, 1, v251
    v_max_i32 v62, 0, v62
    v_cvt_f32_u32 v62, v62
    v_cvt_pk_bf16_f32 v62, v62, v62
    v_lshlrev_b32 v62, 16, v62
    v_cvt_u32_f32 v62, v62
    v_lshrrev_b32 v63, 3, v62
    v_add_u32 v62, v62, v63
    v_lshl_add_u32 v250, v62, 2, s69
    v_add_f32 v242, 0x40e00000, v57
    v_mad_u32_u24 v242, v242, v58, v59
    v_lshrrev_b32 v63, 5, v242
    v_lshl_add_u32 v63, v63, 2, s69
    v_add_u32 v242, v242, v63
    v_add_f32 v243, 0x40c00000, v57
    v_mad_u32_u24 v243, v243, v58, v59
    v_lshrrev_b32 v63, 5, v243
    v_lshl_add_u32 v63, v63, 2, s69
    v_add_u32 v243, v243, v63
    v_add_f32 v244, 0x40a00000, v57
    v_mad_u32_u24 v244, v244, v58, v59
    v_lshrrev_b32 v63, 5, v244
    v_lshl_add_u32 v63, v63, 2, s69
    v_add_u32 v244, v244, v63
    v_add_f32 v245, 0x40800000, v57
    v_mad_u32_u24 v245, v245, v58, v59
    v_lshrrev_b32 v63, 5, v245
    v_lshl_add_u32 v63, v63, 2, s69
    v_add_u32 v245, v245, v63
    v_add_f32 v246, 0x40400000, v57
    v_mad_u32_u24 v246, v246, v58, v59
    v_lshrrev_b32 v63, 5, v246
    v_lshl_add_u32 v63, v63, 2, s69
    v_add_u32 v246, v246, v63
    v_add_f32 v247, 0x40000000, v57
    v_mad_u32_u24 v247, v247, v58, v59
    v_lshrrev_b32 v63, 5, v247
    v_lshl_add_u32 v63, v63, 2, s69
    v_add_u32 v247, v247, v63
    v_add_f32 v248, 0x3f800000, v57
    v_mad_u32_u24 v248, v248, v58, v59
    v_lshrrev_b32 v63, 5, v248
    v_lshl_add_u32 v63, v63, 2, s69
    v_add_u32 v248, v248, v63
    v_add_f32 v249, 0x00000000, v57
    v_mad_u32_u24 v249, v249, v58, v59
    v_lshrrev_b32 v63, 5, v249
    v_lshl_add_u32 v63, v63, 2, s69
    v_add_u32 v249, v249, v63
    s_mul_i32 s59, s54, 14592
    s_add_u32 s59, s59, 98560
    v_lshl_add_u32 v50, v0, 2, s59
    v_and_b32 v54, 31, v0
    v_lshrrev_b32 v55, 5, v0
    v_mul_u32_u24 v52, 272, v54
    v_lshl_add_u32 v52, v55, 4, v52
    v_add_u32 v52, s59, v52
    v_min_u32 v56, 20, v54
    v_mul_u32_u24 v51, 272, v56
    v_lshl_add_u32 v51, v55, 4, v51
    v_add_u32 v51, s59, v51
    v_add_u32 v51, 8704, v51
    v_mul_u32_u24 v53, 36, v54
    v_lshl_add_u32 v53, v55, 4, v53
    v_add_u32 v53, s59, v53
    s_waitcnt lgkmcnt(0)
    s_lshl_b32 s58, s57, 16
    s_and_b32 s57, s57, 0xffff0000
    s_cmp_lt_u32 s54, 2
    s_cselect_b32 s57, s58, s57
    v_mov_b32 v14, 0x3fb8aa3b
    v_mul_f32 v14, s57, v14
    v_exp_f32 v14, v14
    s_nop 0
    v_cvt_pk_bf16_f32 v14, v14, v14
    v_and_b32 v14, 0xffff0000, v14
    v_lshlrev_b32 v2, 16, v2
    v_lshlrev_b32 v3, 16, v3
    v_lshlrev_b32 v4, 16, v4
    v_lshlrev_b32 v5, 16, v5
    v_lshlrev_b32 v6, 16, v6
    v_lshlrev_b32 v7, 16, v7
    v_mul_f32 v16, v14, v2
    v_mul_f32 v17, v14, v3
    v_mul_f32 v16, 0x3fb8aa3b, v16
    v_mul_f32 v17, 0.15915494, v17
    v_mul_f32 v18, v14, v4
    v_mul_f32 v19, v14, v5
    v_pk_mul_f32 v[34:35], v[6:7], v[18:19] op_sel_hi:[0,1]
    v_pk_fma_f32 v[34:35], v[6:7], v[18:19], v[34:35] op_sel:[1,1,0] op_sel_hi:[1,0,1] neg_lo:[1,0,0]
    v_mul_f32 v20, 0x3f800000, v16
    v_mul_f32 v21, 0x3f800000, v17
    v_exp_f32 v20, v20
    v_fract_f32 v21, v21
    v_cos_f32 v22, v21
    v_sin_f32 v23, v21
    s_nop 0
    v_mul_f32 v24, v20, v22
    v_mul_f32 v25, v20, v23
    v_mul_f32 v20, 0x41000000, v16
    v_mul_f32 v21, 0x41000000, v17
    v_exp_f32 v20, v20
    v_fract_f32 v21, v21
    v_cos_f32 v22, v21
    v_sin_f32 v23, v21
    s_nop 0
    v_mul_f32 v26, v20, v22
    v_mul_f32 v27, v20, v23
    v_mul_f32 v20, 0x43800000, v16
    v_mul_f32 v21, 0x43800000, v17
    v_exp_f32 v20, v20
    v_fract_f32 v21, v21
    v_cos_f32 v22, v21
    v_sin_f32 v23, v21
    s_nop 0
    v_mul_f32 v28, v20, v22
    v_mul_f32 v29, v20, v23
    v_mov_b32 v64, 0x3f80
    v_cvt_pk_bf16_f32 v65, v26, v27
    v_cvt_pk_bf16_f32 v96, v34, -v35
    v_pk_mul_f32 v[30:31], v[26:27], v[26:27] op_sel_hi:[0,1]
    v_pk_fma_f32 v[30:31], v[26:27], v[26:27], v[30:31] op_sel:[1,1,0] op_sel_hi:[1,0,1] neg_lo:[1,0,0]
    v_cvt_pk_bf16_f32 v66, v30, v31
    v_pk_mul_f32 v[36:37], v[34:35], v[24:25] op_sel_hi:[0,1]
    v_pk_fma_f32 v[36:37], v[34:35], v[24:25], v[36:37] op_sel:[1,1,0] op_sel_hi:[1,0,1] neg_lo:[1,0,0]
    v_cvt_pk_bf16_f32 v97, v36, -v37
    v_pk_mul_f32 v[32:33], v[30:31], v[26:27] op_sel_hi:[0,1]
    v_pk_fma_f32 v[32:33], v[30:31], v[26:27], v[32:33] op_sel:[1,1,0] op_sel_hi:[1,0,1] neg_lo:[1,0,0]
    v_cvt_pk_bf16_f32 v67, v32, v33
    v_pk_mul_f32 v[38:39], v[36:37], v[24:25] op_sel_hi:[0,1]
    v_pk_fma_f32 v[38:39], v[36:37], v[24:25], v[38:39] op_sel:[1,1,0] op_sel_hi:[1,0,1] neg_lo:[1,0,0]
    v_cvt_pk_bf16_f32 v98, v38, -v39
    v_pk_mul_f32 v[30:31], v[32:33], v[26:27] op_sel_hi:[0,1]
    v_pk_fma_f32 v[30:31], v[32:33], v[26:27], v[30:31] op_sel:[1,1,0] op_sel_hi:[1,0,1] neg_lo:[1,0,0]
    v_cvt_pk_bf16_f32 v68, v30, v31
    v_pk_mul_f32 v[40:41], v[38:39], v[24:25] op_sel_hi:[0,1]
    v_pk_fma_f32 v[40:41], v[38:39], v[24:25], v[40:41] op_sel:[1,1,0] op_sel_hi:[1,0,1] neg_lo:[1,0,0]
    v_cvt_pk_bf16_f32 v99, v40, -v41
    v_pk_mul_f32 v[32:33], v[30:31], v[26:27] op_sel_hi:[0,1]
    v_pk_fma_f32 v[32:33], v[30:31], v[26:27], v[32:33] op_sel:[1,1,0] op_sel_hi:[1,0,1] neg_lo:[1,0,0]
    v_cvt_pk_bf16_f32 v69, v32, v33
    v_pk_mul_f32 v[42:43], v[40:41], v[24:25] op_sel_hi:[0,1]
    v_pk_fma_f32 v[42:43], v[40:41], v[24:25], v[42:43] op_sel:[1,1,0] op_sel_hi:[1,0,1] neg_lo:[1,0,0]
    v_cvt_pk_bf16_f32 v100, v42, -v43
    v_pk_mul_f32 v[30:31], v[32:33], v[26:27] op_sel_hi:[0,1]
    v_pk_fma_f32 v[30:31], v[32:33], v[26:27], v[30:31] op_sel:[1,1,0] op_sel_hi:[1,0,1] neg_lo:[1,0,0]
    v_cvt_pk_bf16_f32 v70, v30, v31
    v_pk_mul_f32 v[44:45], v[42:43], v[24:25] op_sel_hi:[0,1]
    v_pk_fma_f32 v[44:45], v[42:43], v[24:25], v[44:45] op_sel:[1,1,0] op_sel_hi:[1,0,1] neg_lo:[1,0,0]
    v_cvt_pk_bf16_f32 v101, v44, -v45
    v_pk_mul_f32 v[32:33], v[30:31], v[26:27] op_sel_hi:[0,1]
    v_pk_fma_f32 v[32:33], v[30:31], v[26:27], v[32:33] op_sel:[1,1,0] op_sel_hi:[1,0,1] neg_lo:[1,0,0]
    v_cvt_pk_bf16_f32 v71, v32, v33
    v_pk_mul_f32 v[46:47], v[44:45], v[24:25] op_sel_hi:[0,1]
    v_pk_fma_f32 v[46:47], v[44:45], v[24:25], v[46:47] op_sel:[1,1,0] op_sel_hi:[1,0,1] neg_lo:[1,0,0]
    v_cvt_pk_bf16_f32 v102, v46, -v47
    v_pk_mul_f32 v[30:31], v[32:33], v[26:27] op_sel_hi:[0,1]
    v_pk_fma_f32 v[30:31], v[32:33], v[26:27], v[30:31] op_sel:[1,1,0] op_sel_hi:[1,0,1] neg_lo:[1,0,0]
    v_cvt_pk_bf16_f32 v72, v30, v31
    v_pk_mul_f32 v[48:49], v[46:47], v[24:25] op_sel_hi:[0,1]
    v_pk_fma_f32 v[48:49], v[46:47], v[24:25], v[48:49] op_sel:[1,1,0] op_sel_hi:[1,0,1] neg_lo:[1,0,0]
    v_cvt_pk_bf16_f32 v103, v48, -v49
    v_pk_mul_f32 v[32:33], v[30:31], v[26:27] op_sel_hi:[0,1]
    v_pk_fma_f32 v[32:33], v[30:31], v[26:27], v[32:33] op_sel:[1,1,0] op_sel_hi:[1,0,1] neg_lo:[1,0,0]
    v_cvt_pk_bf16_f32 v73, v32, v33
    v_pk_mul_f32 v[56:57], v[38:39], v[28:29] op_sel_hi:[0,1]
    v_pk_fma_f32 v[56:57], v[38:39], v[28:29], v[56:57] op_sel:[1,1,0] op_sel_hi:[1,0,1] neg_lo:[1,0,0]
    v_cvt_pk_bf16_f32 v105, v56, -v57
    v_pk_mul_f32 v[30:31], v[32:33], v[26:27] op_sel_hi:[0,1]
    v_pk_fma_f32 v[30:31], v[32:33], v[26:27], v[30:31] op_sel:[1,1,0] op_sel_hi:[1,0,1] neg_lo:[1,0,0]
    v_cvt_pk_bf16_f32 v74, v30, v31
    v_pk_mul_f32 v[58:59], v[46:47], v[28:29] op_sel_hi:[0,1]
    v_pk_fma_f32 v[58:59], v[46:47], v[28:29], v[58:59] op_sel:[1,1,0] op_sel_hi:[1,0,1] neg_lo:[1,0,0]
    v_cvt_pk_bf16_f32 v109, v58, -v59
    v_pk_mul_f32 v[32:33], v[30:31], v[26:27] op_sel_hi:[0,1]
    v_pk_fma_f32 v[32:33], v[30:31], v[26:27], v[32:33] op_sel:[1,1,0] op_sel_hi:[1,0,1] neg_lo:[1,0,0]
    v_cvt_pk_bf16_f32 v75, v32, v33
    v_pk_mul_f32 v[56:57], v[42:43], v[28:29] op_sel_hi:[0,1]
    v_pk_fma_f32 v[56:57], v[42:43], v[28:29], v[56:57] op_sel:[1,1,0] op_sel_hi:[1,0,1] neg_lo:[1,0,0]
    v_cvt_pk_bf16_f32 v108, v56, -v57
    v_pk_mul_f32 v[30:31], v[32:33], v[26:27] op_sel_hi:[0,1]
    v_pk_fma_f32 v[30:31], v[32:33], v[26:27], v[30:31] op_sel:[1,1,0] op_sel_hi:[1,0,1] neg_lo:[1,0,0]
    v_cvt_pk_bf16_f32 v76, v30, v31
    v_pk_mul_f32 v[58:59], v[56:57], v[28:29] op_sel_hi:[0,1]
    v_pk_fma_f32 v[58:59], v[56:57], v[28:29], v[58:59] op_sel:[1,1,0] op_sel_hi:[1,0,1] neg_lo:[1,0,0]
    v_cvt_pk_bf16_f32 v110, v58, -v59
    v_pk_mul_f32 v[32:33], v[30:31], v[26:27] op_sel_hi:[0,1]
    v_pk_fma_f32 v[32:33], v[30:31], v[26:27], v[32:33] op_sel:[1,1,0] op_sel_hi:[1,0,1] neg_lo:[1,0,0]
    v_cvt_pk_bf16_f32 v77, v32, v33
    v_pk_mul_f32 v[56:57], v[58:59], v[28:29] op_sel_hi:[0,1]
    v_pk_fma_f32 v[56:57], v[58:59], v[28:29], v[56:57] op_sel:[1,1,0] op_sel_hi:[1,0,1] neg_lo:[1,0,0]
    v_cvt_pk_bf16_f32 v111, v56, -v57
    v_pk_mul_f32 v[30:31], v[32:33], v[26:27] op_sel_hi:[0,1]
    v_pk_fma_f32 v[30:31], v[32:33], v[26:27], v[30:31] op_sel:[1,1,0] op_sel_hi:[1,0,1] neg_lo:[1,0,0]
    v_cvt_pk_bf16_f32 v78, v30, v31
    v_pk_mul_f32 v[60:61], v[34:35], v[28:29] op_sel_hi:[0,1]
    v_pk_fma_f32 v[60:61], v[34:35], v[28:29], v[60:61] op_sel:[1,1,0] op_sel_hi:[1,0,1] neg_lo:[1,0,0]
    v_cvt_pk_bf16_f32 v104, v60, -v61
    v_pk_mul_f32 v[32:33], v[30:31], v[26:27] op_sel_hi:[0,1]
    v_pk_fma_f32 v[32:33], v[30:31], v[26:27], v[32:33] op_sel:[1,1,0] op_sel_hi:[1,0,1] neg_lo:[1,0,0]
    v_cvt_pk_bf16_f32 v79, v32, v33
    v_pk_mul_f32 v[62:63], v[60:61], v[28:29] op_sel_hi:[0,1]
    v_pk_fma_f32 v[62:63], v[60:61], v[28:29], v[62:63] op_sel:[1,1,0] op_sel_hi:[1,0,1] neg_lo:[1,0,0]
    v_cvt_pk_bf16_f32 v106, v62, -v63
    v_pk_mul_f32 v[30:31], v[32:33], v[26:27] op_sel_hi:[0,1]
    v_pk_fma_f32 v[30:31], v[32:33], v[26:27], v[30:31] op_sel:[1,1,0] op_sel_hi:[1,0,1] neg_lo:[1,0,0]
    v_cvt_pk_bf16_f32 v80, v30, v31
    v_pk_mul_f32 v[60:61], v[62:63], v[28:29] op_sel_hi:[0,1]
    v_pk_fma_f32 v[60:61], v[62:63], v[28:29], v[60:61] op_sel:[1,1,0] op_sel_hi:[1,0,1] neg_lo:[1,0,0]
    v_cvt_pk_bf16_f32 v107, v60, -v61
    v_pk_mul_f32 v[32:33], v[30:31], v[26:27] op_sel_hi:[0,1]
    v_pk_fma_f32 v[32:33], v[30:31], v[26:27], v[32:33] op_sel:[1,1,0] op_sel_hi:[1,0,1] neg_lo:[1,0,0]
    v_cvt_pk_bf16_f32 v81, v32, v33
    v_pk_mul_f32 v[62:63], v[60:61], v[28:29] op_sel_hi:[0,1]
    v_pk_fma_f32 v[62:63], v[60:61], v[28:29], v[62:63] op_sel:[1,1,0] op_sel_hi:[1,0,1] neg_lo:[1,0,0]
    v_cvt_pk_bf16_f32 v112, v62, -v63
    v_pk_mul_f32 v[30:31], v[32:33], v[26:27] op_sel_hi:[0,1]
    v_pk_fma_f32 v[30:31], v[32:33], v[26:27], v[30:31] op_sel:[1,1,0] op_sel_hi:[1,0,1] neg_lo:[1,0,0]
    v_cvt_pk_bf16_f32 v82, v30, v31
    v_pk_mul_f32 v[60:61], v[62:63], v[28:29] op_sel_hi:[0,1]
    v_pk_fma_f32 v[60:61], v[62:63], v[28:29], v[60:61] op_sel:[1,1,0] op_sel_hi:[1,0,1] neg_lo:[1,0,0]
    v_cvt_pk_bf16_f32 v113, v60, -v61
    v_pk_mul_f32 v[32:33], v[30:31], v[26:27] op_sel_hi:[0,1]
    v_pk_fma_f32 v[32:33], v[30:31], v[26:27], v[32:33] op_sel:[1,1,0] op_sel_hi:[1,0,1] neg_lo:[1,0,0]
    v_cvt_pk_bf16_f32 v83, v32, v33
    v_pk_mul_f32 v[62:63], v[60:61], v[28:29] op_sel_hi:[0,1]
    v_pk_fma_f32 v[62:63], v[60:61], v[28:29], v[62:63] op_sel:[1,1,0] op_sel_hi:[1,0,1] neg_lo:[1,0,0]
    v_cvt_pk_bf16_f32 v114, v62, -v63
    v_pk_mul_f32 v[30:31], v[32:33], v[26:27] op_sel_hi:[0,1]
    v_pk_fma_f32 v[30:31], v[32:33], v[26:27], v[30:31] op_sel:[1,1,0] op_sel_hi:[1,0,1] neg_lo:[1,0,0]
    v_cvt_pk_bf16_f32 v84, v30, v31
    v_pk_mul_f32 v[60:61], v[62:63], v[28:29] op_sel_hi:[0,1]
    v_pk_fma_f32 v[60:61], v[62:63], v[28:29], v[60:61] op_sel:[1,1,0] op_sel_hi:[1,0,1] neg_lo:[1,0,0]
    v_cvt_pk_bf16_f32 v115, v60, -v61
    v_pk_mul_f32 v[32:33], v[30:31], v[26:27] op_sel_hi:[0,1]
    v_pk_fma_f32 v[32:33], v[30:31], v[26:27], v[32:33] op_sel:[1,1,0] op_sel_hi:[1,0,1] neg_lo:[1,0,0]
    v_cvt_pk_bf16_f32 v85, v32, v33
    v_pk_mul_f32 v[62:63], v[60:61], v[28:29] op_sel_hi:[0,1]
    v_pk_fma_f32 v[62:63], v[60:61], v[28:29], v[62:63] op_sel:[1,1,0] op_sel_hi:[1,0,1] neg_lo:[1,0,0]
    v_cvt_pk_bf16_f32 v116, v62, -v63
    v_pk_mul_f32 v[30:31], v[32:33], v[26:27] op_sel_hi:[0,1]
    v_pk_fma_f32 v[30:31], v[32:33], v[26:27], v[30:31] op_sel:[1,1,0] op_sel_hi:[1,0,1] neg_lo:[1,0,0]
    v_cvt_pk_bf16_f32 v86, v30, v31
    v_pk_mul_f32 v[32:33], v[30:31], v[26:27] op_sel_hi:[0,1]
    v_pk_fma_f32 v[32:33], v[30:31], v[26:27], v[32:33] op_sel:[1,1,0] op_sel_hi:[1,0,1] neg_lo:[1,0,0]
    v_cvt_pk_bf16_f32 v87, v32, v33
    v_pk_mul_f32 v[30:31], v[32:33], v[26:27] op_sel_hi:[0,1]
    v_pk_fma_f32 v[30:31], v[32:33], v[26:27], v[30:31] op_sel:[1,1,0] op_sel_hi:[1,0,1] neg_lo:[1,0,0]
    v_cvt_pk_bf16_f32 v88, v30, v31
    v_pk_mul_f32 v[32:33], v[30:31], v[26:27] op_sel_hi:[0,1]
    v_pk_fma_f32 v[32:33], v[30:31], v[26:27], v[32:33] op_sel:[1,1,0] op_sel_hi:[1,0,1] neg_lo:[1,0,0]
    v_cvt_pk_bf16_f32 v89, v32, v33
    v_pk_mul_f32 v[30:31], v[32:33], v[26:27] op_sel_hi:[0,1]
    v_pk_fma_f32 v[30:31], v[32:33], v[26:27], v[30:31] op_sel:[1,1,0] op_sel_hi:[1,0,1] neg_lo:[1,0,0]
    v_cvt_pk_bf16_f32 v90, v30, v31
    v_pk_mul_f32 v[32:33], v[30:31], v[26:27] op_sel_hi:[0,1]
    v_pk_fma_f32 v[32:33], v[30:31], v[26:27], v[32:33] op_sel:[1,1,0] op_sel_hi:[1,0,1] neg_lo:[1,0,0]
    v_cvt_pk_bf16_f32 v91, v32, v33
    v_pk_mul_f32 v[30:31], v[32:33], v[26:27] op_sel_hi:[0,1]
    v_pk_fma_f32 v[30:31], v[32:33], v[26:27], v[30:31] op_sel:[1,1,0] op_sel_hi:[1,0,1] neg_lo:[1,0,0]
    v_cvt_pk_bf16_f32 v92, v30, v31
    v_pk_mul_f32 v[32:33], v[30:31], v[26:27] op_sel_hi:[0,1]
    v_pk_fma_f32 v[32:33], v[30:31], v[26:27], v[32:33] op_sel:[1,1,0] op_sel_hi:[1,0,1] neg_lo:[1,0,0]
    v_cvt_pk_bf16_f32 v93, v32, v33
    v_pk_mul_f32 v[30:31], v[32:33], v[26:27] op_sel_hi:[0,1]
    v_pk_fma_f32 v[30:31], v[32:33], v[26:27], v[30:31] op_sel:[1,1,0] op_sel_hi:[1,0,1] neg_lo:[1,0,0]
    v_cvt_pk_bf16_f32 v94, v30, v31
    v_pk_mul_f32 v[32:33], v[30:31], v[26:27] op_sel_hi:[0,1]
    v_pk_fma_f32 v[32:33], v[30:31], v[26:27], v[32:33] op_sel:[1,1,0] op_sel_hi:[1,0,1] neg_lo:[1,0,0]
    v_cvt_pk_bf16_f32 v95, v32, v33
    s_waitcnt vmcnt(0)
    s_branch L_tail
H_g:
    s_add_u32 s60, s48, 0x600000
    s_addc_u32 s61, s49, 0
    s_mov_b32 s62, 0x158000
    s_mov_b32 s63, 0x20000
    s_mov_b32 s70, s3
    s_mul_i32 s68, s70, 180224
    s_lshl_b32 s69, s71, 11
    s_add_u32 s68, s68, s69
    v_lshl_add_u32 v11, v0, 4, s68
    s_and_b32 s68, s5, 3
    s_mul_i32 s68, s68, 3
    s_add_u32 s68, s68, s71
    s_sub_u32 s69, s68, 11
    s_cmp_ge_u32 s68, 11
    s_cselect_b32 s68, s69, s68
    s_mov_b32 s68, 10
    s_lshl_b32 s96, s68, 14
    s_lshl_b32 s97, s68, 11
    s_lshl_b32 s68, s72, 1
    s_load_dword s98, s[32:33], s68
    s_lshl_b32 s68, s71, 7
    s_lshl_b32 s69, s4, 7
    v_min_u32 v24, 21, v0
    v_lshl_add_u32 v24, v24, 10, s68
    v_and_b32 v25, 31, v0
    v_lshl_add_u32 v25, v25, 10, s69
    v_cmp_gt_u32 vcc, 32, v0
    s_nop 1
    v_cndmask_b32 v24, v25, v24, vcc
    s_cmp_eq_u32 s3, 0
    s_cselect_b32 s68, 0, 0x100000
    s_cselect_b32 s69, 1, 0
    v_add_u32 v24, s68, v24
    buffer_load_dwordx4 v[20:23], v24, s[64:67], 0 offen sc1
    v_mov_b32 v25, s69
    s_barrier
    s_mov_b32 s70, 0
    s_waitcnt vmcnt(0)
H_pe:
    v_and_b32 v20, v20, v21
    v_and_b32 v20, v20, v22
    v_and_b32 v20, v20, v23
    v_and_b32 v20, v20, v25
    v_cmp_ne_u32 vcc, v20, v25
    s_nop 4
    s_cbranch_vccz H_pe_ok
    s_add_u32 s70, s70, 1
    s_cmp_lt_u32 s70, 0x40000
    s_cbranch_scc0 H_pe_ok
    s_sleep 1
    buffer_load_dwordx4 v[20:23], v24, s[64:67], 0 offen sc1
    s_waitcnt vmcnt(0)
    s_branch H_pe
H_pe_ok:
    s_barrier
    s_add_u32 s96, s96, 16384
    s_cmp_eq_u32 s96, 180224
    s_cselect_b32 s96, 0, s96
    v_add_u32 v15, s96, v11
    buffer_load_dwordx4 v[168:171], v15, s[60:63], 0 offen sc1
    buffer_load_dwordx4 v[172:175], v15, s[60:63], 0 offen offset:1024 sc1
    s_add_u32 s96, s96, 16384
    s_cmp_eq_u32 s96, 180224
    s_cselect_b32 s96, 0, s96
    v_add_u32 v15, s96, v11
    buffer_load_dwordx4 v[176:179], v15, s[60:63], 0 offen sc1
    buffer_load_dwordx4 v[180:183], v15, s[60:63], 0 offen offset:1024 sc1
    s_add_u32 s96, s96, 16384
    s_cmp_eq_u32 s96, 180224
    s_cselect_b32 s96, 0, s96
    v_add_u32 v15, s96, v11
    buffer_load_dwordx4 v[184:187], v15, s[60:63], 0 offen sc1
    buffer_load_dwordx4 v[188:191], v15, s[60:63], 0 offen offset:1024 sc1
    s_add_u32 s96, s96, 16384
    s_cmp_eq_u32 s96, 180224
    s_cselect_b32 s96, 0, s96
    v_add_u32 v15, s96, v11
    buffer_load_dwordx4 v[192:195], v15, s[60:63], 0 offen sc1
    buffer_load_dwordx4 v[196:199], v15, s[60:63], 0 offen offset:1024 sc1
    s_barrier
    s_branch K_b1
K_gemm:
    s_lshl_b32 s8, s5, 2
    s_add_u32 s8, s8, s3
    s_lshl_b32 s8, s8, 14
    s_lshl_b32 s9, s4, 7
    s_add_u32 s9, s9, s8
    v_lshrrev_b32 v20, 3, v0
    v_lshlrev_b32 v20, 10, v20
    v_and_b32 v21, 7, v0
    v_lshl_add_u32 v20, v21, 4, v20
    v_add_u32 v20, s9, v20
    v_add_u32 v21, 0x2000, v20
    s_lshl_b32 s9, s4, 11
    s_add_u32 s9, s9, s8
    v_lshl_add_u32 v22, v0, 4, s9
    s_waitcnt lgkmcnt(0)
    s_mov_b32 s56, s40
    s_mov_b32 s57, s41
    s_mov_b32 s58, 0x158000
    s_mov_b32 s59, 0x20000
    s_mov_b32 s52, s16
    s_mov_b32 s53, s17
    s_mov_b32 s54, 0x200000
    s_mov_b32 s55, 0x20000
    buffer_load_dwordx4 v[176:179], v20, s[56:59], 0 offen
    buffer_load_dwordx4 v[180:183], v21, s[56:59], 0 offen
    buffer_load_dwordx4 v[184:187], v20, s[52:55], 0 offen
    buffer_load_dwordx4 v[188:191], v21, s[52:55], 0 offen
    v_and_b32 v31, 31, v0
    v_lshlrev_b32 v31, 5, v31
    v_lshrrev_b32 v24, 5, v0
    v_lshl_add_u32 v31, v24, 4, v31
    v_add_u32 v31, s9, v31
    s_lshl_b32 s8, s3, 12
    s_add_u32 s8, s8, 131072
    v_lshl_add_u32 v23, v0, 4, s8
    v_bfe_u32 v25, v0, 2, 2
    v_lshlrev_b32 v25, 7, v25
    v_bfe_u32 v21, v0, 4, 1
    v_lshl_add_u32 v25, v21, 5, v25
    v_and_b32 v21, 3, v0
    v_lshl_add_u32 v25, v21, 3, v25
    v_add_u32 v25, s8, v25
    v_lshl_add_u32 v21, v24, 10, v25
    v_lshl_add_u32 v24, v24, 9, v25
    s_add_u32 s52, s48, 0x800000
    s_addc_u32 s53, s49, 0
    s_mov_b32 s54, 0x200000
    s_mov_b32 s55, 0x20000
    s_add_u32 s56, s48, 0x600000
    s_addc_u32 s57, s49, 0
    s_mov_b32 s58, 0x158000
    s_mov_b32 s59, 0x20000
    s_add_u32 s64, s48, 0x1300000
    s_addc_u32 s65, s49, 0
    s_mov_b32 s66, 0x18000
    s_mov_b32 s67, 0x20000
    s_lshl_b32 s68, s2, 7
    s_lshl_b32 s69, s3, 2
    s_add_u32 s68, s68, s69
    s_add_u32 s68, s68, 0
    v_lshl_add_u32 v26, v0, 20, s68
    v_mov_b32 v27, 1
    s_and_b32 s8, s3, 1
    s_lshr_b32 s9, s3, 1
    v_and_b32 v8, 15, v0
    v_lshrrev_b32 v9, 4, v0
    v_and_b32 v10, 1, v9
    v_lshrrev_b32 v11, 1, v9
    v_mul_u32_u24 v2, 6176, v10
    v_lshrrev_b32 v12, 2, v8
    v_lshl_add_u32 v12, v11, 3, v12
    v_mul_u32_u24 v12, 192, v12
    v_add_u32 v2, v2, v12
    v_and_b32 v12, 3, v8
    v_lshl_add_u32 v2, v12, 3, v2
    s_mul_i32 s10, s9, 96
    s_add_u32 s10, s10, 49152
    v_add_u32 v2, s10, v2
    v_add_u32 v3, 36960, v2
    v_and_b32 v8, 31, v0
    s_lshl_b32 s10, s8, 6
    v_add_u32 v8, s10, v8
    v_bfe_u32 v9, v8, 1, 3
    v_lshlrev_b32 v8, 7, v8
    v_add_u32 v10, 0, v11
    v_xor_b32 v10, v10, v9
    v_lshl_add_u32 v4, v10, 4, v8
    v_add_u32 v10, 2, v11
    v_xor_b32 v10, v10, v9
    v_lshl_add_u32 v5, v10, 4, v8
    v_add_u32 v10, 4, v11
    v_xor_b32 v10, v10, v9
    v_lshl_add_u32 v6, v10, 4, v8
    v_add_u32 v10, 6, v11
    v_xor_b32 v10, v10, v9
    v_lshl_add_u32 v7, v10, 4, v8
    s_mul_i32 s10, s7, 6
    s_mul_i32 s11, s9, 3
    s_add_u32 s10, s10, s11
    s_lshl_b32 s10, s10, 11
    s_lshl_b32 s11, s6, 1
    s_add_u32 s11, s11, s8
    v_lshlrev_b32 v12, 4, v0
    v_add_u32 v12, s10, v12
    v_add_u32 v13, 0x800, v12
    v_add_u32 v14, 0x1000, v12
    v_mov_b32 v16, 0xc0135761
    v_mov_b32 v17, 0xc0135761
    v_mov_b32 v18, 0xbdd2d3e8
    v_mov_b32 v19, 0xbdd2d3e8
    s_waitcnt lgkmcnt(0)
    s_mul_i32 s14, s11, 176128
    s_add_u32 s12, s48, s14
    s_addc_u32 s13, s49, 0
    s_mov_b32 s14, 176128
    s_mov_b32 s15, 0x20000
    s_add_u32 s60, s48, 0x600000
    s_addc_u32 s61, s49, 0
    s_mov_b32 s62, 0x158000
    s_mov_b32 s63, 0x20000
    s_mov_b32 s70, s3
    s_mul_i32 s68, s70, 180224
    s_lshl_b32 s69, s71, 11
    s_add_u32 s68, s68, s69
    v_lshl_add_u32 v11, v0, 4, s68
    s_and_b32 s68, s5, 3
    s_mul_i32 s68, s68, 3
    s_add_u32 s68, s68, s71
    s_sub_u32 s69, s68, 11
    s_cmp_ge_u32 s68, 11
    s_cselect_b32 s68, s69, s68
    s_mov_b32 s68, 10
    s_lshl_b32 s96, s68, 14
    s_lshl_b32 s97, s68, 11
    s_lshl_b32 s68, s72, 1
    s_load_dword s98, s[32:33], s68
    s_mov_b32 s76, s46
    s_mov_b32 s77, s47
    s_mov_b32 s78, 0x100
    s_mov_b32 s79, 0x20000
    s_and_b32 s68, s5, 3
    s_lshl_b32 s68, s68, 6
    s_cmp_eq_u32 s3, 0
    s_cselect_b32 s68, s68, 0x1000
    s_cselect_b32 s69, 0x01010101, 0
    v_and_b32 v28, 3, v0
    v_lshl_add_u32 v28, v28, 2, s68
    v_mov_b32 v30, s69
    s_waitcnt lgkmcnt(0)
    s_barrier
    ds_read_b128 v[140:143], v4 offset:0
    ds_read_b64_tr_b16 v[128:129], v2 offset:0
    ds_read_b64_tr_b16 v[130:131], v2 offset:768
    ds_read_b128 v[144:147], v4 offset:4096
    ds_read_b64_tr_b16 v[132:133], v2 offset:32
    ds_read_b64_tr_b16 v[134:135], v2 offset:800
    ds_read_b64_tr_b16 v[136:137], v2 offset:64
    ds_read_b64_tr_b16 v[138:139], v2 offset:832
    s_waitcnt lgkmcnt(0)
    s_waitcnt vmcnt(0)
    ds_write_b128 v23, v[176:179] offset:0
    ds_write_b128 v23, v[180:183] offset:1024
    ds_write_b128 v23, v[184:187] offset:2048
    ds_write_b128 v23, v[188:191] offset:3072
    v_mfma_f32_32x32x16_bf16 v[32:47], v[128:131], v[140:143], 0
    ds_read_b128 v[160:163], v5 offset:0
    ds_read_b64_tr_b16 v[148:149], v2 offset:3072
    ds_read_b64_tr_b16 v[150:151], v2 offset:3840
    v_mfma_f32_32x32x16_bf16 v[80:95], v[128:131], v[144:147], 0
    ds_read_b128 v[164:167], v5 offset:4096
    ds_read_b64_tr_b16 v[152:153], v2 offset:3104
    ds_read_b64_tr_b16 v[154:155], v2 offset:3872
    v_mfma_f32_32x32x16_bf16 v[48:63], v[132:135], v[140:143], 0
    ds_read_b64_tr_b16 v[156:157], v2 offset:3136
    ds_read_b64_tr_b16 v[158:159], v2 offset:3904
    v_mfma_f32_32x32x16_bf16 v[96:111], v[132:135], v[144:147], 0
    v_mfma_f32_32x32x16_bf16 v[64:79], v[136:139], v[140:143], 0
    v_mfma_f32_32x32x16_bf16 v[112:127], v[136:139], v[144:147], 0
    s_waitcnt lgkmcnt(0)
    ds_read_b64_tr_b16 v[176:177], v24 offset:0
    ds_read_b64_tr_b16 v[178:179], v24 offset:1024
    ds_read_b64_tr_b16 v[180:181], v24 offset:64
    ds_read_b64_tr_b16 v[182:183], v24 offset:1088
    ds_read_b64_tr_b16 v[184:185], v21 offset:2048
    ds_read_b64_tr_b16 v[186:187], v21 offset:2560
    ds_read_b64_tr_b16 v[188:189], v21 offset:2112
    ds_read_b64_tr_b16 v[190:191], v21 offset:2624
    v_mfma_f32_32x32x16_bf16 v[32:47], v[148:151], v[160:163], v[32:47]
    ds_read_b128 v[140:143], v6 offset:0
    ds_read_b64_tr_b16 v[128:129], v2 offset:12320
    ds_read_b64_tr_b16 v[130:131], v2 offset:13088
    v_mfma_f32_32x32x16_bf16 v[80:95], v[148:151], v[164:167], v[80:95]
    ds_read_b128 v[144:147], v6 offset:4096
    ds_read_b64_tr_b16 v[132:133], v2 offset:12352
    ds_read_b64_tr_b16 v[134:135], v2 offset:13120
    v_mfma_f32_32x32x16_bf16 v[48:63], v[152:155], v[160:163], v[48:63]
    ds_read_b64_tr_b16 v[136:137], v2 offset:12384
    ds_read_b64_tr_b16 v[138:139], v2 offset:13152
    v_mfma_f32_32x32x16_bf16 v[96:111], v[152:155], v[164:167], v[96:111]
    v_mfma_f32_32x32x16_bf16 v[64:79], v[156:159], v[160:163], v[64:79]
    v_mfma_f32_32x32x16_bf16 v[112:127], v[156:159], v[164:167], v[112:127]
    s_waitcnt lgkmcnt(0)
    s_waitcnt lgkmcnt(0)
    buffer_store_dwordx4 v[176:179], v22, s[56:59], 0 offen sc1
    buffer_store_dwordx4 v[180:183], v22, s[56:59], 0 offen offset:1024 sc1
    buffer_store_dwordx4 v[184:187], v31, s[52:55], 0 offen sc1
    buffer_store_dwordx4 v[188:191], v31, s[52:55], 0 offen offset:1024 sc1
    s_lshl_b32 s68, s72, 12
    s_lshl_b32 s69, s3, 10
    s_add_u32 s68, s68, s69
    s_add_u32 s68, s68, 0x1000000
    v_lshl_add_u32 v196, v0, 4, s68
    v_add_u32 v197, 0x1000, v196
    v_mov_b32 v192, -1
    v_mov_b32 v193, -1
    v_mov_b32 v194, -1
    v_mov_b32 v195, -1
    global_store_dwordx4 v196, v[192:195], s[48:49] sc1
    global_store_dwordx4 v197, v[192:195], s[48:49] sc1
    v_mfma_f32_32x32x16_bf16 v[32:47], v[128:131], v[140:143], v[32:47]
    ds_read_b128 v[160:163], v7 offset:0
    ds_read_b64_tr_b16 v[148:149], v2 offset:15392
    ds_read_b64_tr_b16 v[150:151], v2 offset:16160
    v_mfma_f32_32x32x16_bf16 v[80:95], v[128:131], v[144:147], v[80:95]
    ds_read_b128 v[164:167], v7 offset:4096
    ds_read_b64_tr_b16 v[152:153], v2 offset:15424
    ds_read_b64_tr_b16 v[154:155], v2 offset:16192
    v_mfma_f32_32x32x16_bf16 v[48:63], v[132:135], v[140:143], v[48:63]
    ds_read_b64_tr_b16 v[156:157], v2 offset:15456
    ds_read_b64_tr_b16 v[158:159], v2 offset:16224
    v_mfma_f32_32x32x16_bf16 v[96:111], v[132:135], v[144:147], v[96:111]
    v_mfma_f32_32x32x16_bf16 v[64:79], v[136:139], v[140:143], v[64:79]
    v_mfma_f32_32x32x16_bf16 v[112:127], v[136:139], v[144:147], v[112:127]
    s_waitcnt lgkmcnt(0)
    s_barrier
    v_mfma_f32_32x32x16_bf16 v[32:47], v[148:151], v[160:163], v[32:47]
    ds_read_b128 v[140:143], v4 offset:16384
    ds_read_b64_tr_b16 v[128:129], v2 offset:24640
    ds_read_b64_tr_b16 v[130:131], v2 offset:25408
    v_mfma_f32_32x32x16_bf16 v[80:95], v[148:151], v[164:167], v[80:95]
    ds_read_b128 v[144:147], v4 offset:20480
    ds_read_b64_tr_b16 v[132:133], v2 offset:24672
    ds_read_b64_tr_b16 v[134:135], v2 offset:25440
    v_mfma_f32_32x32x16_bf16 v[48:63], v[152:155], v[160:163], v[48:63]
    ds_read_b64_tr_b16 v[136:137], v2 offset:24704
    ds_read_b64_tr_b16 v[138:139], v2 offset:25472
    v_mfma_f32_32x32x16_bf16 v[96:111], v[152:155], v[164:167], v[96:111]
    v_mfma_f32_32x32x16_bf16 v[64:79], v[156:159], v[160:163], v[64:79]
    v_mfma_f32_32x32x16_bf16 v[112:127], v[156:159], v[164:167], v[112:127]
    s_waitcnt lgkmcnt(5)
    v_mfma_f32_32x32x16_bf16 v[32:47], v[128:131], v[140:143], v[32:47]
    ds_read_b128 v[160:163], v5 offset:16384
    ds_read_b64_tr_b16 v[148:149], v2 offset:27712
    ds_read_b64_tr_b16 v[150:151], v2 offset:28480
    s_waitcnt lgkmcnt(7)
    v_mfma_f32_32x32x16_bf16 v[80:95], v[128:131], v[144:147], v[80:95]
    ds_read_b128 v[164:167], v5 offset:20480
    ds_read_b64_tr_b16 v[152:153], v2 offset:27744
    ds_read_b64_tr_b16 v[154:155], v2 offset:28512
    s_waitcnt lgkmcnt(8)
    v_mfma_f32_32x32x16_bf16 v[48:63], v[132:135], v[140:143], v[48:63]
    ds_read_b64_tr_b16 v[156:157], v2 offset:27776
    ds_read_b64_tr_b16 v[158:159], v2 offset:28544
    v_mfma_f32_32x32x16_bf16 v[96:111], v[132:135], v[144:147], v[96:111]
    s_waitcnt lgkmcnt(8)
    v_mfma_f32_32x32x16_bf16 v[64:79], v[136:139], v[140:143], v[64:79]
    v_mfma_f32_32x32x16_bf16 v[112:127], v[136:139], v[144:147], v[112:127]
    buffer_load_dword v29, v28, s[76:79], 0 offen sc1
    s_waitcnt lgkmcnt(5)
    v_mfma_f32_32x32x16_bf16 v[32:47], v[148:151], v[160:163], v[32:47]
    ds_read_b128 v[140:143], v6 offset:16384
    ds_read_b64_tr_b16 v[128:129], v3 offset:0
    ds_read_b64_tr_b16 v[130:131], v3 offset:768
    s_waitcnt lgkmcnt(7)
    v_mfma_f32_32x32x16_bf16 v[80:95], v[148:151], v[164:167], v[80:95]
    ds_read_b128 v[144:147], v6 offset:20480
    ds_read_b64_tr_b16 v[132:133], v3 offset:32
    ds_read_b64_tr_b16 v[134:135], v3 offset:800
    s_waitcnt lgkmcnt(8)
    v_mfma_f32_32x32x16_bf16 v[48:63], v[152:155], v[160:163], v[48:63]
    ds_read_b64_tr_b16 v[136:137], v3 offset:64
    ds_read_b64_tr_b16 v[138:139], v3 offset:832
    v_mfma_f32_32x32x16_bf16 v[96:111], v[152:155], v[164:167], v[96:111]
    s_waitcnt lgkmcnt(8)
    v_mfma_f32_32x32x16_bf16 v[64:79], v[156:159], v[160:163], v[64:79]
    v_mfma_f32_32x32x16_bf16 v[112:127], v[156:159], v[164:167], v[112:127]
    s_waitcnt lgkmcnt(5)
    v_mfma_f32_32x32x16_bf16 v[32:47], v[128:131], v[140:143], v[32:47]
    ds_read_b128 v[160:163], v7 offset:16384
    ds_read_b64_tr_b16 v[148:149], v3 offset:3072
    ds_read_b64_tr_b16 v[150:151], v3 offset:3840
    s_waitcnt lgkmcnt(7)
    v_mfma_f32_32x32x16_bf16 v[80:95], v[128:131], v[144:147], v[80:95]
    ds_read_b128 v[164:167], v7 offset:20480
    ds_read_b64_tr_b16 v[152:153], v3 offset:3104
    ds_read_b64_tr_b16 v[154:155], v3 offset:3872
    s_waitcnt lgkmcnt(8)
    v_mfma_f32_32x32x16_bf16 v[48:63], v[132:135], v[140:143], v[48:63]
    ds_read_b64_tr_b16 v[156:157], v3 offset:3136
    ds_read_b64_tr_b16 v[158:159], v3 offset:3904
    v_mfma_f32_32x32x16_bf16 v[96:111], v[132:135], v[144:147], v[96:111]
    s_waitcnt lgkmcnt(8)
    v_mfma_f32_32x32x16_bf16 v[64:79], v[136:139], v[140:143], v[64:79]
    v_mfma_f32_32x32x16_bf16 v[112:127], v[136:139], v[144:147], v[112:127]
    s_waitcnt lgkmcnt(0)
    s_barrier
    v_mfma_f32_32x32x16_bf16 v[32:47], v[148:151], v[160:163], v[32:47]
    ds_read_b128 v[140:143], v4 offset:32768
    ds_read_b64_tr_b16 v[128:129], v3 offset:12320
    ds_read_b64_tr_b16 v[130:131], v3 offset:13088
    v_mfma_f32_32x32x16_bf16 v[80:95], v[148:151], v[164:167], v[80:95]
    ds_read_b128 v[144:147], v4 offset:36864
    ds_read_b64_tr_b16 v[132:133], v3 offset:12352
    ds_read_b64_tr_b16 v[134:135], v3 offset:13120
    v_mfma_f32_32x32x16_bf16 v[48:63], v[152:155], v[160:163], v[48:63]
    ds_read_b64_tr_b16 v[136:137], v3 offset:12384
    ds_read_b64_tr_b16 v[138:139], v3 offset:13152
    v_mfma_f32_32x32x16_bf16 v[96:111], v[152:155], v[164:167], v[96:111]
    v_mfma_f32_32x32x16_bf16 v[64:79], v[156:159], v[160:163], v[64:79]
    v_mfma_f32_32x32x16_bf16 v[112:127], v[156:159], v[164:167], v[112:127]
    s_waitcnt lgkmcnt(5)
    v_mfma_f32_32x32x16_bf16 v[32:47], v[128:131], v[140:143], v[32:47]
    ds_read_b128 v[160:163], v5 offset:32768
    ds_read_b64_tr_b16 v[148:149], v3 offset:15392
    ds_read_b64_tr_b16 v[150:151], v3 offset:16160
    s_waitcnt lgkmcnt(7)
    v_mfma_f32_32x32x16_bf16 v[80:95], v[128:131], v[144:147], v[80:95]
    ds_read_b128 v[164:167], v5 offset:36864
    ds_read_b64_tr_b16 v[152:153], v3 offset:15424
    ds_read_b64_tr_b16 v[154:155], v3 offset:16192
    s_waitcnt lgkmcnt(8)
    v_mfma_f32_32x32x16_bf16 v[48:63], v[132:135], v[140:143], v[48:63]
    ds_read_b64_tr_b16 v[156:157], v3 offset:15456
    ds_read_b64_tr_b16 v[158:159], v3 offset:16224
    v_mfma_f32_32x32x16_bf16 v[96:111], v[132:135], v[144:147], v[96:111]
    s_waitcnt lgkmcnt(8)
    v_mfma_f32_32x32x16_bf16 v[64:79], v[136:139], v[140:143], v[64:79]
    v_mfma_f32_32x32x16_bf16 v[112:127], v[136:139], v[144:147], v[112:127]
    s_waitcnt lgkmcnt(5)
    v_mfma_f32_32x32x16_bf16 v[32:47], v[148:151], v[160:163], v[32:47]
    ds_read_b128 v[140:143], v6 offset:32768
    ds_read_b64_tr_b16 v[128:129], v3 offset:24640
    ds_read_b64_tr_b16 v[130:131], v3 offset:25408
    s_waitcnt lgkmcnt(7)
    v_mfma_f32_32x32x16_bf16 v[80:95], v[148:151], v[164:167], v[80:95]
    ds_read_b128 v[144:147], v6 offset:36864
    ds_read_b64_tr_b16 v[132:133], v3 offset:24672
    ds_read_b64_tr_b16 v[134:135], v3 offset:25440
    s_waitcnt lgkmcnt(8)
    v_mfma_f32_32x32x16_bf16 v[48:63], v[152:155], v[160:163], v[48:63]
    ds_read_b64_tr_b16 v[136:137], v3 offset:24704
    ds_read_b64_tr_b16 v[138:139], v3 offset:25472
    v_mfma_f32_32x32x16_bf16 v[96:111], v[152:155], v[164:167], v[96:111]
    s_waitcnt lgkmcnt(8)
    v_mfma_f32_32x32x16_bf16 v[64:79], v[156:159], v[160:163], v[64:79]
    v_mfma_f32_32x32x16_bf16 v[112:127], v[156:159], v[164:167], v[112:127]
    s_waitcnt lgkmcnt(5)
    v_mfma_f32_32x32x16_bf16 v[32:47], v[128:131], v[140:143], v[32:47]
    ds_read_b128 v[160:163], v7 offset:32768
    ds_read_b64_tr_b16 v[148:149], v3 offset:27712
    ds_read_b64_tr_b16 v[150:151], v3 offset:28480
    s_waitcnt lgkmcnt(7)
    v_mfma_f32_32x32x16_bf16 v[80:95], v[128:131], v[144:147], v[80:95]
    ds_read_b128 v[164:167], v7 offset:36864
    ds_read_b64_tr_b16 v[152:153], v3 offset:27744
    ds_read_b64_tr_b16 v[154:155], v3 offset:28512
    s_waitcnt lgkmcnt(8)
    v_mfma_f32_32x32x16_bf16 v[48:63], v[132:135], v[140:143], v[48:63]
    ds_read_b64_tr_b16 v[156:157], v3 offset:27776
    ds_read_b64_tr_b16 v[158:159], v3 offset:28544
    v_mfma_f32_32x32x16_bf16 v[96:111], v[132:135], v[144:147], v[96:111]
    s_waitcnt lgkmcnt(8)
    v_mfma_f32_32x32x16_bf16 v[64:79], v[136:139], v[140:143], v[64:79]
    v_mfma_f32_32x32x16_bf16 v[112:127], v[136:139], v[144:147], v[112:127]
    s_mov_b32 s70, 0
    s_waitcnt vmcnt(0)
G_pz:
    v_and_b32 v29, v29, v30
    v_cmp_ne_u32 vcc, v29, v30
    s_nop 4
    s_cbranch_vccz G_pz_ok
    s_add_u32 s70, s70, 1
    s_cmp_lt_u32 s70, 0x40000
    s_cbranch_scc0 G_pz_ok
    s_sleep 1
    buffer_load_dword v29, v28, s[76:79], 0 offen sc1
    s_waitcnt vmcnt(0)
    s_branch G_pz
G_pz_ok:
    s_waitcnt lgkmcnt(0)
    s_barrier
    v_mfma_f32_32x32x16_bf16 v[32:47], v[148:151], v[160:163], v[32:47]
    ds_read_b128 v[140:143], v4 offset:0
    ds_read_b64_tr_b16 v[128:129], v2 offset:0
    ds_read_b64_tr_b16 v[130:131], v2 offset:768
    v_mfma_f32_32x32x16_bf16 v[80:95], v[148:151], v[164:167], v[80:95]
    ds_read_b128 v[144:147], v4 offset:4096
    ds_read_b64_tr_b16 v[132:133], v2 offset:32
    ds_read_b64_tr_b16 v[134:135], v2 offset:800
    v_mfma_f32_32x32x16_bf16 v[48:63], v[152:155], v[160:163], v[48:63]
    ds_read_b64_tr_b16 v[136:137], v2 offset:64
    ds_read_b64_tr_b16 v[138:139], v2 offset:832
    v_mfma_f32_32x32x16_bf16 v[96:111], v[152:155], v[164:167], v[96:111]
    v_mfma_f32_32x32x16_bf16 v[64:79], v[156:159], v[160:163], v[64:79]
    v_mfma_f32_32x32x16_bf16 v[112:127], v[156:159], v[164:167], v[112:127]
    s_waitcnt lgkmcnt(5)
    v_mfma_f32_32x32x16_bf16 v[32:47], v[128:131], v[140:143], v[32:47]
    ds_read_b128 v[160:163], v5 offset:0
    ds_read_b64_tr_b16 v[148:149], v2 offset:3072
    ds_read_b64_tr_b16 v[150:151], v2 offset:3840
    s_waitcnt lgkmcnt(7)
    v_mfma_f32_32x32x16_bf16 v[80:95], v[128:131], v[144:147], v[80:95]
    ds_read_b128 v[164:167], v5 offset:4096
    ds_read_b64_tr_b16 v[152:153], v2 offset:3104
    ds_read_b64_tr_b16 v[154:155], v2 offset:3872
    s_waitcnt lgkmcnt(8)
    v_mfma_f32_32x32x16_bf16 v[48:63], v[132:135], v[140:143], v[48:63]
    ds_read_b64_tr_b16 v[156:157], v2 offset:3136
    ds_read_b64_tr_b16 v[158:159], v2 offset:3904
    v_mfma_f32_32x32x16_bf16 v[96:111], v[132:135], v[144:147], v[96:111]
    s_waitcnt lgkmcnt(8)
    v_mfma_f32_32x32x16_bf16 v[64:79], v[136:139], v[140:143], v[64:79]
    v_mfma_f32_32x32x16_bf16 v[112:127], v[136:139], v[144:147], v[112:127]
    buffer_store_dword v27, v26, s[64:67], 0 offen sc1
    s_waitcnt lgkmcnt(5)
    v_mfma_f32_32x32x16_bf16 v[32:47], v[148:151], v[160:163], v[32:47]
    ds_read_b128 v[140:143], v6 offset:0
    ds_read_b64_tr_b16 v[128:129], v2 offset:12320
    ds_read_b64_tr_b16 v[130:131], v2 offset:13088
    s_waitcnt lgkmcnt(7)
    v_mfma_f32_32x32x16_bf16 v[80:95], v[148:151], v[164:167], v[80:95]
    ds_read_b128 v[144:147], v6 offset:4096
    ds_read_b64_tr_b16 v[132:133], v2 offset:12352
    ds_read_b64_tr_b16 v[134:135], v2 offset:13120
    s_waitcnt lgkmcnt(8)
    v_mfma_f32_32x32x16_bf16 v[48:63], v[152:155], v[160:163], v[48:63]
    ds_read_b64_tr_b16 v[136:137], v2 offset:12384
    ds_read_b64_tr_b16 v[138:139], v2 offset:13152
    v_mfma_f32_32x32x16_bf16 v[96:111], v[152:155], v[164:167], v[96:111]
    s_waitcnt lgkmcnt(8)
    v_mfma_f32_32x32x16_bf16 v[64:79], v[156:159], v[160:163], v[64:79]
    v_mfma_f32_32x32x16_bf16 v[112:127], v[156:159], v[164:167], v[112:127]
    s_waitcnt lgkmcnt(5)
    v_mfma_f32_32x32x16_bf16 v[32:47], v[128:131], v[140:143], v[32:47]
    ds_read_b128 v[160:163], v7 offset:0
    ds_read_b64_tr_b16 v[148:149], v2 offset:15392
    ds_read_b64_tr_b16 v[150:151], v2 offset:16160
    s_waitcnt lgkmcnt(7)
    v_mfma_f32_32x32x16_bf16 v[80:95], v[128:131], v[144:147], v[80:95]
    ds_read_b128 v[164:167], v7 offset:4096
    ds_read_b64_tr_b16 v[152:153], v2 offset:15424
    ds_read_b64_tr_b16 v[154:155], v2 offset:16192
    s_waitcnt lgkmcnt(8)
    v_mfma_f32_32x32x16_bf16 v[48:63], v[132:135], v[140:143], v[48:63]
    ds_read_b64_tr_b16 v[156:157], v2 offset:15456
    ds_read_b64_tr_b16 v[158:159], v2 offset:16224
    v_mfma_f32_32x32x16_bf16 v[96:111], v[132:135], v[144:147], v[96:111]
    s_waitcnt lgkmcnt(8)
    v_mfma_f32_32x32x16_bf16 v[64:79], v[136:139], v[140:143], v[64:79]
    v_mfma_f32_32x32x16_bf16 v[112:127], v[136:139], v[144:147], v[112:127]
    s_waitcnt lgkmcnt(0)
    s_barrier
    v_mfma_f32_32x32x16_bf16 v[32:47], v[148:151], v[160:163], v[32:47]
    ds_read_b128 v[140:143], v4 offset:16384
    ds_read_b64_tr_b16 v[128:129], v2 offset:24640
    ds_read_b64_tr_b16 v[130:131], v2 offset:25408
    v_mfma_f32_32x32x16_bf16 v[80:95], v[148:151], v[164:167], v[80:95]
    ds_read_b128 v[144:147], v4 offset:20480
    ds_read_b64_tr_b16 v[132:133], v2 offset:24672
    ds_read_b64_tr_b16 v[134:135], v2 offset:25440
    v_mfma_f32_32x32x16_bf16 v[48:63], v[152:155], v[160:163], v[48:63]
    ds_read_b64_tr_b16 v[136:137], v2 offset:24704
    ds_read_b64_tr_b16 v[138:139], v2 offset:25472
    v_mfma_f32_32x32x16_bf16 v[96:111], v[152:155], v[164:167], v[96:111]
    v_mfma_f32_32x32x16_bf16 v[64:79], v[156:159], v[160:163], v[64:79]
    v_mfma_f32_32x32x16_bf16 v[112:127], v[156:159], v[164:167], v[112:127]
    s_waitcnt lgkmcnt(5)
    v_mfma_f32_32x32x16_bf16 v[32:47], v[128:131], v[140:143], v[32:47]
    ds_read_b128 v[160:163], v5 offset:16384
    ds_read_b64_tr_b16 v[148:149], v2 offset:27712
    ds_read_b64_tr_b16 v[150:151], v2 offset:28480
    s_waitcnt lgkmcnt(7)
    v_mfma_f32_32x32x16_bf16 v[80:95], v[128:131], v[144:147], v[80:95]
    ds_read_b128 v[164:167], v5 offset:20480
    ds_read_b64_tr_b16 v[152:153], v2 offset:27744
    ds_read_b64_tr_b16 v[154:155], v2 offset:28512
    s_waitcnt lgkmcnt(8)
    v_mfma_f32_32x32x16_bf16 v[48:63], v[132:135], v[140:143], v[48:63]
    ds_read_b64_tr_b16 v[156:157], v2 offset:27776
    ds_read_b64_tr_b16 v[158:159], v2 offset:28544
    v_mfma_f32_32x32x16_bf16 v[96:111], v[132:135], v[144:147], v[96:111]
    s_waitcnt lgkmcnt(8)
    v_mfma_f32_32x32x16_bf16 v[64:79], v[136:139], v[140:143], v[64:79]
    v_mfma_f32_32x32x16_bf16 v[112:127], v[136:139], v[144:147], v[112:127]
    s_waitcnt lgkmcnt(5)
    v_mfma_f32_32x32x16_bf16 v[32:47], v[148:151], v[160:163], v[32:47]
    ds_read_b128 v[140:143], v6 offset:16384
    ds_read_b64_tr_b16 v[128:129], v3 offset:0
    ds_read_b64_tr_b16 v[130:131], v3 offset:768
    s_waitcnt lgkmcnt(7)
    v_mfma_f32_32x32x16_bf16 v[80:95], v[148:151], v[164:167], v[80:95]
    ds_read_b128 v[144:147], v6 offset:20480
    ds_read_b64_tr_b16 v[132:133], v3 offset:32
    ds_read_b64_tr_b16 v[134:135], v3 offset:800
    s_waitcnt lgkmcnt(8)
    v_mfma_f32_32x32x16_bf16 v[48:63], v[152:155], v[160:163], v[48:63]
    ds_read_b64_tr_b16 v[136:137], v3 offset:64
    ds_read_b64_tr_b16 v[138:139], v3 offset:832
    v_mfma_f32_32x32x16_bf16 v[96:111], v[152:155], v[164:167], v[96:111]
    s_waitcnt lgkmcnt(8)
    v_mfma_f32_32x32x16_bf16 v[64:79], v[156:159], v[160:163], v[64:79]
    v_mfma_f32_32x32x16_bf16 v[112:127], v[156:159], v[164:167], v[112:127]
    s_waitcnt lgkmcnt(5)
    v_mfma_f32_32x32x16_bf16 v[32:47], v[128:131], v[140:143], v[32:47]
    ds_read_b128 v[160:163], v7 offset:16384
    ds_read_b64_tr_b16 v[148:149], v3 offset:3072
    ds_read_b64_tr_b16 v[150:151], v3 offset:3840
    s_waitcnt lgkmcnt(7)
    v_mfma_f32_32x32x16_bf16 v[80:95], v[128:131], v[144:147], v[80:95]
    ds_read_b128 v[164:167], v7 offset:20480
    ds_read_b64_tr_b16 v[152:153], v3 offset:3104
    ds_read_b64_tr_b16 v[154:155], v3 offset:3872
    s_waitcnt lgkmcnt(8)
    v_mfma_f32_32x32x16_bf16 v[48:63], v[132:135], v[140:143], v[48:63]
    ds_read_b64_tr_b16 v[156:157], v3 offset:3136
    ds_read_b64_tr_b16 v[158:159], v3 offset:3904
    v_mfma_f32_32x32x16_bf16 v[96:111], v[132:135], v[144:147], v[96:111]
    s_waitcnt lgkmcnt(8)
    v_mfma_f32_32x32x16_bf16 v[64:79], v[136:139], v[140:143], v[64:79]
    v_mfma_f32_32x32x16_bf16 v[112:127], v[136:139], v[144:147], v[112:127]
    s_waitcnt lgkmcnt(0)
    s_barrier
    v_mfma_f32_32x32x16_bf16 v[32:47], v[148:151], v[160:163], v[32:47]
    ds_read_b128 v[140:143], v4 offset:32768
    ds_read_b64_tr_b16 v[128:129], v3 offset:12320
    ds_read_b64_tr_b16 v[130:131], v3 offset:13088
    v_mfma_f32_32x32x16_bf16 v[80:95], v[148:151], v[164:167], v[80:95]
    ds_read_b128 v[144:147], v4 offset:36864
    ds_read_b64_tr_b16 v[132:133], v3 offset:12352
    ds_read_b64_tr_b16 v[134:135], v3 offset:13120
    v_mfma_f32_32x32x16_bf16 v[48:63], v[152:155], v[160:163], v[48:63]
    ds_read_b64_tr_b16 v[136:137], v3 offset:12384
    ds_read_b64_tr_b16 v[138:139], v3 offset:13152
    v_mfma_f32_32x32x16_bf16 v[96:111], v[152:155], v[164:167], v[96:111]
    v_mfma_f32_32x32x16_bf16 v[64:79], v[156:159], v[160:163], v[64:79]
    v_mfma_f32_32x32x16_bf16 v[112:127], v[156:159], v[164:167], v[112:127]
    s_waitcnt lgkmcnt(5)
    v_mfma_f32_32x32x16_bf16 v[32:47], v[128:131], v[140:143], v[32:47]
    ds_read_b128 v[160:163], v5 offset:32768
    ds_read_b64_tr_b16 v[148:149], v3 offset:15392
    ds_read_b64_tr_b16 v[150:151], v3 offset:16160
    s_waitcnt lgkmcnt(7)
    v_mfma_f32_32x32x16_bf16 v[80:95], v[128:131], v[144:147], v[80:95]
    ds_read_b128 v[164:167], v5 offset:36864
    ds_read_b64_tr_b16 v[152:153], v3 offset:15424
    ds_read_b64_tr_b16 v[154:155], v3 offset:16192
    s_waitcnt lgkmcnt(8)
    v_mfma_f32_32x32x16_bf16 v[48:63], v[132:135], v[140:143], v[48:63]
    ds_read_b64_tr_b16 v[156:157], v3 offset:15456
    ds_read_b64_tr_b16 v[158:159], v3 offset:16224
    v_mfma_f32_32x32x16_bf16 v[96:111], v[132:135], v[144:147], v[96:111]
    s_waitcnt lgkmcnt(8)
    v_mfma_f32_32x32x16_bf16 v[64:79], v[136:139], v[140:143], v[64:79]
    v_mfma_f32_32x32x16_bf16 v[112:127], v[136:139], v[144:147], v[112:127]
    s_waitcnt lgkmcnt(5)
    v_mfma_f32_32x32x16_bf16 v[32:47], v[148:151], v[160:163], v[32:47]
    ds_read_b128 v[140:143], v6 offset:32768
    ds_read_b64_tr_b16 v[128:129], v3 offset:24640
    ds_read_b64_tr_b16 v[130:131], v3 offset:25408
    s_waitcnt lgkmcnt(7)
    v_mfma_f32_32x32x16_bf16 v[80:95], v[148:151], v[164:167], v[80:95]
    ds_read_b128 v[144:147], v6 offset:36864
    ds_read_b64_tr_b16 v[132:133], v3 offset:24672
    ds_read_b64_tr_b16 v[134:135], v3 offset:25440
    s_waitcnt lgkmcnt(8)
    v_mfma_f32_32x32x16_bf16 v[48:63], v[152:155], v[160:163], v[48:63]
    ds_read_b64_tr_b16 v[136:137], v3 offset:24704
    ds_read_b64_tr_b16 v[138:139], v3 offset:25472
    v_mfma_f32_32x32x16_bf16 v[96:111], v[152:155], v[164:167], v[96:111]
    s_waitcnt lgkmcnt(8)
    v_mfma_f32_32x32x16_bf16 v[64:79], v[156:159], v[160:163], v[64:79]
    v_mfma_f32_32x32x16_bf16 v[112:127], v[156:159], v[164:167], v[112:127]
    s_waitcnt lgkmcnt(5)
    v_mfma_f32_32x32x16_bf16 v[32:47], v[128:131], v[140:143], v[32:47]
    ds_read_b128 v[160:163], v7 offset:32768
    ds_read_b64_tr_b16 v[148:149], v3 offset:27712
    ds_read_b64_tr_b16 v[150:151], v3 offset:28480
    s_waitcnt lgkmcnt(7)
    v_mfma_f32_32x32x16_bf16 v[80:95], v[128:131], v[144:147], v[80:95]
    ds_read_b128 v[164:167], v7 offset:36864
    ds_read_b64_tr_b16 v[152:153], v3 offset:27744
    ds_read_b64_tr_b16 v[154:155], v3 offset:28512
    s_waitcnt lgkmcnt(8)
    v_mfma_f32_32x32x16_bf16 v[48:63], v[132:135], v[140:143], v[48:63]
    ds_read_b64_tr_b16 v[156:157], v3 offset:27776
    ds_read_b64_tr_b16 v[158:159], v3 offset:28544
    v_mfma_f32_32x32x16_bf16 v[96:111], v[132:135], v[144:147], v[96:111]
    s_waitcnt lgkmcnt(8)
    v_mfma_f32_32x32x16_bf16 v[64:79], v[136:139], v[140:143], v[64:79]
    v_mfma_f32_32x32x16_bf16 v[112:127], v[136:139], v[144:147], v[112:127]
    s_lshl_b32 s68, s71, 7
    s_lshl_b32 s69, s4, 7
    v_min_u32 v24, 21, v0
    v_lshl_add_u32 v24, v24, 10, s68
    v_and_b32 v25, 31, v0
    v_lshl_add_u32 v25, v25, 10, s69
    v_cmp_gt_u32 vcc, 32, v0
    s_nop 1
    v_cndmask_b32 v24, v25, v24, vcc
    s_cmp_eq_u32 s3, 0
    s_cselect_b32 s68, 0, 0x100000
    s_cselect_b32 s69, 1, 0
    v_add_u32 v24, s68, v24
    buffer_load_dwordx4 v[20:23], v24, s[64:67], 0 offen sc1
    v_mov_b32 v25, s69
    s_waitcnt lgkmcnt(0)
    s_barrier
    v_mfma_f32_32x32x16_bf16 v[32:47], v[148:151], v[160:163], v[32:47]
    ds_read_b128 v[140:143], v4 offset:0
    ds_read_b64_tr_b16 v[128:129], v2 offset:0
    ds_read_b64_tr_b16 v[130:131], v2 offset:768
    v_mfma_f32_32x32x16_bf16 v[80:95], v[148:151], v[164:167], v[80:95]
    ds_read_b128 v[144:147], v4 offset:4096
    ds_read_b64_tr_b16 v[132:133], v2 offset:32
    ds_read_b64_tr_b16 v[134:135], v2 offset:800
    v_mfma_f32_32x32x16_bf16 v[48:63], v[152:155], v[160:163], v[48:63]
    ds_read_b64_tr_b16 v[136:137], v2 offset:64
    ds_read_b64_tr_b16 v[138:139], v2 offset:832
    v_mfma_f32_32x32x16_bf16 v[96:111], v[152:155], v[164:167], v[96:111]
    v_mfma_f32_32x32x16_bf16 v[64:79], v[156:159], v[160:163], v[64:79]
    v_mfma_f32_32x32x16_bf16 v[112:127], v[156:159], v[164:167], v[112:127]
    s_waitcnt lgkmcnt(5)
    v_mfma_f32_32x32x16_bf16 v[32:47], v[128:131], v[140:143], v[32:47]
    ds_read_b128 v[160:163], v5 offset:0
    ds_read_b64_tr_b16 v[148:149], v2 offset:3072
    ds_read_b64_tr_b16 v[150:151], v2 offset:3840
    s_waitcnt lgkmcnt(7)
    v_mfma_f32_32x32x16_bf16 v[80:95], v[128:131], v[144:147], v[80:95]
    ds_read_b128 v[164:167], v5 offset:4096
    ds_read_b64_tr_b16 v[152:153], v2 offset:3104
    ds_read_b64_tr_b16 v[154:155], v2 offset:3872
    s_waitcnt lgkmcnt(8)
    v_mfma_f32_32x32x16_bf16 v[48:63], v[132:135], v[140:143], v[48:63]
    ds_read_b64_tr_b16 v[156:157], v2 offset:3136
    ds_read_b64_tr_b16 v[158:159], v2 offset:3904
    v_mfma_f32_32x32x16_bf16 v[96:111], v[132:135], v[144:147], v[96:111]
    s_waitcnt lgkmcnt(8)
    v_mfma_f32_32x32x16_bf16 v[64:79], v[136:139], v[140:143], v[64:79]
    v_mfma_f32_32x32x16_bf16 v[112:127], v[136:139], v[144:147], v[112:127]
    s_waitcnt lgkmcnt(5)
    v_mfma_f32_32x32x16_bf16 v[32:47], v[148:151], v[160:163], v[32:47]
    ds_read_b128 v[140:143], v6 offset:0
    ds_read_b64_tr_b16 v[128:129], v2 offset:12320
    ds_read_b64_tr_b16 v[130:131], v2 offset:13088
    s_waitcnt lgkmcnt(7)
    v_mfma_f32_32x32x16_bf16 v[80:95], v[148:151], v[164:167], v[80:95]
    ds_read_b128 v[144:147], v6 offset:4096
    ds_read_b64_tr_b16 v[132:133], v2 offset:12352
    ds_read_b64_tr_b16 v[134:135], v2 offset:13120
    s_waitcnt lgkmcnt(8)
    v_mfma_f32_32x32x16_bf16 v[48:63], v[152:155], v[160:163], v[48:63]
    ds_read_b64_tr_b16 v[136:137], v2 offset:12384
    ds_read_b64_tr_b16 v[138:139], v2 offset:13152
    v_mfma_f32_32x32x16_bf16 v[96:111], v[152:155], v[164:167], v[96:111]
    s_waitcnt lgkmcnt(8)
    v_mfma_f32_32x32x16_bf16 v[64:79], v[156:159], v[160:163], v[64:79]
    v_mfma_f32_32x32x16_bf16 v[112:127], v[156:159], v[164:167], v[112:127]
    s_waitcnt lgkmcnt(5)
    v_mfma_f32_32x32x16_bf16 v[32:47], v[128:131], v[140:143], v[32:47]
    ds_read_b128 v[160:163], v7 offset:0
    ds_read_b64_tr_b16 v[148:149], v2 offset:15392
    ds_read_b64_tr_b16 v[150:151], v2 offset:16160
    s_waitcnt lgkmcnt(7)
    v_mfma_f32_32x32x16_bf16 v[80:95], v[128:131], v[144:147], v[80:95]
    ds_read_b128 v[164:167], v7 offset:4096
    ds_read_b64_tr_b16 v[152:153], v2 offset:15424
    ds_read_b64_tr_b16 v[154:155], v2 offset:16192
    s_waitcnt lgkmcnt(8)
    v_mfma_f32_32x32x16_bf16 v[48:63], v[132:135], v[140:143], v[48:63]
    ds_read_b64_tr_b16 v[156:157], v2 offset:15456
    ds_read_b64_tr_b16 v[158:159], v2 offset:16224
    v_mfma_f32_32x32x16_bf16 v[96:111], v[132:135], v[144:147], v[96:111]
    s_waitcnt lgkmcnt(8)
    v_mfma_f32_32x32x16_bf16 v[64:79], v[136:139], v[140:143], v[64:79]
    v_mfma_f32_32x32x16_bf16 v[112:127], v[136:139], v[144:147], v[112:127]
    s_mov_b32 s70, 0
    s_waitcnt vmcnt(0)
G_pe:
    v_and_b32 v20, v20, v21
    v_and_b32 v20, v20, v22
    v_and_b32 v20, v20, v23
    v_and_b32 v20, v20, v25
    v_cmp_ne_u32 vcc, v20, v25
    s_nop 4
    s_cbranch_vccz G_pe_ok
    s_add_u32 s70, s70, 1
    s_cmp_lt_u32 s70, 0x40000
    s_cbranch_scc0 G_pe_ok
    s_sleep 1
    buffer_load_dwordx4 v[20:23], v24, s[64:67], 0 offen sc1
    s_waitcnt vmcnt(0)
    s_branch G_pe
G_pe_ok:
    s_waitcnt lgkmcnt(0)
    s_barrier
    v_mfma_f32_32x32x16_bf16 v[32:47], v[148:151], v[160:163], v[32:47]
    ds_read_b128 v[140:143], v4 offset:16384
    ds_read_b64_tr_b16 v[128:129], v2 offset:24640
    ds_read_b64_tr_b16 v[130:131], v2 offset:25408
    v_mfma_f32_32x32x16_bf16 v[80:95], v[148:151], v[164:167], v[80:95]
    ds_read_b128 v[144:147], v4 offset:20480
    ds_read_b64_tr_b16 v[132:133], v2 offset:24672
    ds_read_b64_tr_b16 v[134:135], v2 offset:25440
    v_mfma_f32_32x32x16_bf16 v[48:63], v[152:155], v[160:163], v[48:63]
    ds_read_b64_tr_b16 v[136:137], v2 offset:24704
    ds_read_b64_tr_b16 v[138:139], v2 offset:25472
    v_mfma_f32_32x32x16_bf16 v[96:111], v[152:155], v[164:167], v[96:111]
    v_mfma_f32_32x32x16_bf16 v[64:79], v[156:159], v[160:163], v[64:79]
    s_add_u32 s96, s96, 16384
    s_cmp_eq_u32 s96, 180224
    s_cselect_b32 s96, 0, s96
    v_add_u32 v15, s96, v11
    buffer_load_dwordx4 v[168:171], v15, s[60:63], 0 offen sc1
    v_mfma_f32_32x32x16_bf16 v[112:127], v[156:159], v[164:167], v[112:127]
    buffer_load_dwordx4 v[172:175], v15, s[60:63], 0 offen offset:1024 sc1
    s_waitcnt lgkmcnt(5)
    v_mfma_f32_32x32x16_bf16 v[32:47], v[128:131], v[140:143], v[32:47]
    ds_read_b128 v[160:163], v5 offset:16384
    ds_read_b64_tr_b16 v[148:149], v2 offset:27712
    ds_read_b64_tr_b16 v[150:151], v2 offset:28480
    s_waitcnt lgkmcnt(7)
    v_mfma_f32_32x32x16_bf16 v[80:95], v[128:131], v[144:147], v[80:95]
    ds_read_b128 v[164:167], v5 offset:20480
    ds_read_b64_tr_b16 v[152:153], v2 offset:27744
    ds_read_b64_tr_b16 v[154:155], v2 offset:28512
    s_waitcnt lgkmcnt(8)
    v_mfma_f32_32x32x16_bf16 v[48:63], v[132:135], v[140:143], v[48:63]
    ds_read_b64_tr_b16 v[156:157], v2 offset:27776
    ds_read_b64_tr_b16 v[158:159], v2 offset:28544
    v_mfma_f32_32x32x16_bf16 v[96:111], v[132:135], v[144:147], v[96:111]
    s_waitcnt lgkmcnt(8)
    v_mfma_f32_32x32x16_bf16 v[64:79], v[136:139], v[140:143], v[64:79]
    s_add_u32 s96, s96, 16384
    s_cmp_eq_u32 s96, 180224
    s_cselect_b32 s96, 0, s96
    v_add_u32 v15, s96, v11
    buffer_load_dwordx4 v[176:179], v15, s[60:63], 0 offen sc1
    v_mfma_f32_32x32x16_bf16 v[112:127], v[136:139], v[144:147], v[112:127]
    buffer_load_dwordx4 v[180:183], v15, s[60:63], 0 offen offset:1024 sc1
    s_waitcnt lgkmcnt(5)
    v_mfma_f32_32x32x16_bf16 v[32:47], v[148:151], v[160:163], v[32:47]
    ds_read_b128 v[140:143], v6 offset:16384
    ds_read_b64_tr_b16 v[128:129], v3 offset:0
    ds_read_b64_tr_b16 v[130:131], v3 offset:768
    s_waitcnt lgkmcnt(7)
    v_mfma_f32_32x32x16_bf16 v[80:95], v[148:151], v[164:167], v[80:95]
    ds_read_b128 v[144:147], v6 offset:20480
    ds_read_b64_tr_b16 v[132:133], v3 offset:32
    ds_read_b64_tr_b16 v[134:135], v3 offset:800
    s_waitcnt lgkmcnt(8)
    v_mfma_f32_32x32x16_bf16 v[48:63], v[152:155], v[160:163], v[48:63]
    ds_read_b64_tr_b16 v[136:137], v3 offset:64
    ds_read_b64_tr_b16 v[138:139], v3 offset:832
    v_mfma_f32_32x32x16_bf16 v[96:111], v[152:155], v[164:167], v[96:111]
    s_waitcnt lgkmcnt(8)
    v_mfma_f32_32x32x16_bf16 v[64:79], v[156:159], v[160:163], v[64:79]
    s_add_u32 s96, s96, 16384
    s_cmp_eq_u32 s96, 180224
    s_cselect_b32 s96, 0, s96
    v_add_u32 v15, s96, v11
    buffer_load_dwordx4 v[184:187], v15, s[60:63], 0 offen sc1
    v_mfma_f32_32x32x16_bf16 v[112:127], v[156:159], v[164:167], v[112:127]
    buffer_load_dwordx4 v[188:191], v15, s[60:63], 0 offen offset:1024 sc1
    s_waitcnt lgkmcnt(5)
    v_mfma_f32_32x32x16_bf16 v[32:47], v[128:131], v[140:143], v[32:47]
    ds_read_b128 v[160:163], v7 offset:16384
    ds_read_b64_tr_b16 v[148:149], v3 offset:3072
    ds_read_b64_tr_b16 v[150:151], v3 offset:3840
    s_waitcnt lgkmcnt(7)
    v_mfma_f32_32x32x16_bf16 v[80:95], v[128:131], v[144:147], v[80:95]
    ds_read_b128 v[164:167], v7 offset:20480
    ds_read_b64_tr_b16 v[152:153], v3 offset:3104
    ds_read_b64_tr_b16 v[154:155], v3 offset:3872
    s_waitcnt lgkmcnt(8)
    v_mfma_f32_32x32x16_bf16 v[48:63], v[132:135], v[140:143], v[48:63]
    ds_read_b64_tr_b16 v[156:157], v3 offset:3136
    ds_read_b64_tr_b16 v[158:159], v3 offset:3904
    v_mfma_f32_32x32x16_bf16 v[96:111], v[132:135], v[144:147], v[96:111]
    s_waitcnt lgkmcnt(8)
    v_mfma_f32_32x32x16_bf16 v[64:79], v[136:139], v[140:143], v[64:79]
    s_add_u32 s96, s96, 16384
    s_cmp_eq_u32 s96, 180224
    s_cselect_b32 s96, 0, s96
    v_add_u32 v15, s96, v11
    buffer_load_dwordx4 v[192:195], v15, s[60:63], 0 offen sc1
    v_mfma_f32_32x32x16_bf16 v[112:127], v[136:139], v[144:147], v[112:127]
    buffer_load_dwordx4 v[196:199], v15, s[60:63], 0 offen offset:1024 sc1
    s_waitcnt lgkmcnt(5)
    v_mfma_f32_32x32x16_bf16 v[32:47], v[148:151], v[160:163], v[32:47]
    s_waitcnt lgkmcnt(4)
    v_mfma_f32_32x32x16_bf16 v[80:95], v[148:151], v[164:167], v[80:95]
    s_waitcnt lgkmcnt(2)
    v_mfma_f32_32x32x16_bf16 v[48:63], v[152:155], v[160:163], v[48:63]
    v_mfma_f32_32x32x16_bf16 v[96:111], v[152:155], v[164:167], v[96:111]
    s_waitcnt lgkmcnt(0)
    v_mfma_f32_32x32x16_bf16 v[64:79], v[156:159], v[160:163], v[64:79]
    v_mfma_f32_32x32x16_bf16 v[112:127], v[156:159], v[164:167], v[112:127]
    s_nop 3
    v_pk_mul_f32 v[128:129], v[32:33], v[32:33]
    v_pk_mul_f32 v[130:131], v[34:35], v[34:35]
    v_pk_mul_f32 v[132:133], v[36:37], v[36:37]
    v_pk_mul_f32 v[134:135], v[38:39], v[38:39]
    v_pk_fma_f32 v[128:129], v[128:129], v[18:19], v[16:17]
    v_pk_fma_f32 v[130:131], v[130:131], v[18:19], v[16:17]
    v_pk_fma_f32 v[132:133], v[132:133], v[18:19], v[16:17]
    v_pk_fma_f32 v[134:135], v[134:135], v[18:19], v[16:17]
    v_pk_mul_f32 v[128:129], v[128:129], v[32:33]
    v_pk_mul_f32 v[130:131], v[130:131], v[34:35]
    v_pk_mul_f32 v[132:133], v[132:133], v[36:37]
    v_pk_mul_f32 v[134:135], v[134:135], v[38:39]
    v_exp_f32 v128, v128
    v_exp_f32 v129, v129
    v_exp_f32 v130, v130
    v_exp_f32 v131, v131
    v_exp_f32 v132, v132
    v_exp_f32 v133, v133
    v_exp_f32 v134, v134
    v_exp_f32 v135, v135
    v_pk_mul_f32 v[32:33], v[32:33], v[40:41]
    v_pk_mul_f32 v[34:35], v[34:35], v[42:43]
    v_pk_mul_f32 v[36:37], v[36:37], v[44:45]
    v_pk_mul_f32 v[38:39], v[38:39], v[46:47]
    v_pk_add_f32 v[128:129], v[128:129], 1.0 op_sel_hi:[1,0]
    v_pk_add_f32 v[130:131], v[130:131], 1.0 op_sel_hi:[1,0]
    v_pk_add_f32 v[132:133], v[132:133], 1.0 op_sel_hi:[1,0]
    v_pk_add_f32 v[134:135], v[134:135], 1.0 op_sel_hi:[1,0]
    v_rcp_f32 v128, v128
    v_rcp_f32 v129, v129
    v_rcp_f32 v130, v130
    v_rcp_f32 v131, v131
    v_rcp_f32 v132, v132
    v_rcp_f32 v133, v133
    v_rcp_f32 v134, v134
    v_rcp_f32 v135, v135
    v_pk_mul_f32 v[32:33], v[32:33], v[128:129]
    v_pk_mul_f32 v[34:35], v[34:35], v[130:131]
    v_pk_mul_f32 v[36:37], v[36:37], v[132:133]
    v_pk_mul_f32 v[38:39], v[38:39], v[134:135]
    v_cvt_pk_bf16_f32 v136, v32, v33
    v_cvt_pk_bf16_f32 v137, v34, v35
    v_cvt_pk_bf16_f32 v138, v36, v37
    v_cvt_pk_bf16_f32 v139, v38, v39
    buffer_store_dwordx4 v[136:139], v12, s[12:15], 0 offen offset:0 sc1
    s_barrier
    v_pk_mul_f32 v[144:145], v[80:81], v[80:81]
    v_pk_mul_f32 v[146:147], v[82:83], v[82:83]
    v_pk_mul_f32 v[148:149], v[84:85], v[84:85]
    v_pk_mul_f32 v[150:151], v[86:87], v[86:87]
    v_pk_fma_f32 v[144:145], v[144:145], v[18:19], v[16:17]
    v_pk_fma_f32 v[146:147], v[146:147], v[18:19], v[16:17]
    v_pk_fma_f32 v[148:149], v[148:149], v[18:19], v[16:17]
    v_pk_fma_f32 v[150:151], v[150:151], v[18:19], v[16:17]
    v_pk_mul_f32 v[144:145], v[144:145], v[80:81]
    v_pk_mul_f32 v[146:147], v[146:147], v[82:83]
    v_pk_mul_f32 v[148:149], v[148:149], v[84:85]
    v_pk_mul_f32 v[150:151], v[150:151], v[86:87]
    v_exp_f32 v144, v144
    v_exp_f32 v145, v145
    v_exp_f32 v146, v146
    v_exp_f32 v147, v147
    v_exp_f32 v148, v148
    v_exp_f32 v149, v149
    v_exp_f32 v150, v150
    v_exp_f32 v151, v151
    v_pk_mul_f32 v[80:81], v[80:81], v[88:89]
    v_pk_mul_f32 v[82:83], v[82:83], v[90:91]
    v_pk_mul_f32 v[84:85], v[84:85], v[92:93]
    v_pk_mul_f32 v[86:87], v[86:87], v[94:95]
    v_pk_add_f32 v[144:145], v[144:145], 1.0 op_sel_hi:[1,0]
    v_pk_add_f32 v[146:147], v[146:147], 1.0 op_sel_hi:[1,0]
    v_pk_add_f32 v[148:149], v[148:149], 1.0 op_sel_hi:[1,0]
    v_pk_add_f32 v[150:151], v[150:151], 1.0 op_sel_hi:[1,0]
    v_rcp_f32 v144, v144
    v_rcp_f32 v145, v145
    v_rcp_f32 v146, v146
    v_rcp_f32 v147, v147
    v_rcp_f32 v148, v148
    v_rcp_f32 v149, v149
    v_rcp_f32 v150, v150
    v_rcp_f32 v151, v151
    v_pk_mul_f32 v[80:81], v[80:81], v[144:145]
    v_pk_mul_f32 v[82:83], v[82:83], v[146:147]
    v_pk_mul_f32 v[84:85], v[84:85], v[148:149]
    v_pk_mul_f32 v[86:87], v[86:87], v[150:151]
    v_cvt_pk_bf16_f32 v152, v80, v81
    v_cvt_pk_bf16_f32 v153, v82, v83
    v_cvt_pk_bf16_f32 v154, v84, v85
    v_cvt_pk_bf16_f32 v155, v86, v87
    buffer_store_dwordx4 v[152:155], v12, s[12:15], 0 offen offset:1024 sc1
    v_pk_mul_f32 v[128:129], v[48:49], v[48:49]
    v_pk_mul_f32 v[130:131], v[50:51], v[50:51]
    v_pk_mul_f32 v[132:133], v[52:53], v[52:53]
    v_pk_mul_f32 v[134:135], v[54:55], v[54:55]
    v_pk_fma_f32 v[128:129], v[128:129], v[18:19], v[16:17]
    v_pk_fma_f32 v[130:131], v[130:131], v[18:19], v[16:17]
    v_pk_fma_f32 v[132:133], v[132:133], v[18:19], v[16:17]
    v_pk_fma_f32 v[134:135], v[134:135], v[18:19], v[16:17]
    v_pk_mul_f32 v[128:129], v[128:129], v[48:49]
    v_pk_mul_f32 v[130:131], v[130:131], v[50:51]
    v_pk_mul_f32 v[132:133], v[132:133], v[52:53]
    v_pk_mul_f32 v[134:135], v[134:135], v[54:55]
    v_exp_f32 v128, v128
    v_exp_f32 v129, v129
    v_exp_f32 v130, v130
    v_exp_f32 v131, v131
    v_exp_f32 v132, v132
    v_exp_f32 v133, v133
    v_exp_f32 v134, v134
    v_exp_f32 v135, v135
    v_pk_mul_f32 v[48:49], v[48:49], v[56:57]
    v_pk_mul_f32 v[50:51], v[50:51], v[58:59]
    v_pk_mul_f32 v[52:53], v[52:53], v[60:61]
    v_pk_mul_f32 v[54:55], v[54:55], v[62:63]
    v_pk_add_f32 v[128:129], v[128:129], 1.0 op_sel_hi:[1,0]
    v_pk_add_f32 v[130:131], v[130:131], 1.0 op_sel_hi:[1,0]
    v_pk_add_f32 v[132:133], v[132:133], 1.0 op_sel_hi:[1,0]
    v_pk_add_f32 v[134:135], v[134:135], 1.0 op_sel_hi:[1,0]
    v_rcp_f32 v128, v128
    v_rcp_f32 v129, v129
    v_rcp_f32 v130, v130
    v_rcp_f32 v131, v131
    v_rcp_f32 v132, v132
    v_rcp_f32 v133, v133
    v_rcp_f32 v134, v134
    v_rcp_f32 v135, v135
    v_pk_mul_f32 v[48:49], v[48:49], v[128:129]
    v_pk_mul_f32 v[50:51], v[50:51], v[130:131]
    v_pk_mul_f32 v[52:53], v[52:53], v[132:133]
    v_pk_mul_f32 v[54:55], v[54:55], v[134:135]
    v_cvt_pk_bf16_f32 v136, v48, v49
    v_cvt_pk_bf16_f32 v137, v50, v51
    v_cvt_pk_bf16_f32 v138, v52, v53
    v_cvt_pk_bf16_f32 v139, v54, v55
    buffer_store_dwordx4 v[136:139], v13, s[12:15], 0 offen offset:0 sc1
    v_pk_mul_f32 v[144:145], v[96:97], v[96:97]
    v_pk_mul_f32 v[146:147], v[98:99], v[98:99]
    v_pk_mul_f32 v[148:149], v[100:101], v[100:101]
    v_pk_mul_f32 v[150:151], v[102:103], v[102:103]
    v_pk_fma_f32 v[144:145], v[144:145], v[18:19], v[16:17]
    v_pk_fma_f32 v[146:147], v[146:147], v[18:19], v[16:17]
    v_pk_fma_f32 v[148:149], v[148:149], v[18:19], v[16:17]
    v_pk_fma_f32 v[150:151], v[150:151], v[18:19], v[16:17]
    v_pk_mul_f32 v[144:145], v[144:145], v[96:97]
    v_pk_mul_f32 v[146:147], v[146:147], v[98:99]
    v_pk_mul_f32 v[148:149], v[148:149], v[100:101]
    v_pk_mul_f32 v[150:151], v[150:151], v[102:103]
    v_exp_f32 v144, v144
    v_exp_f32 v145, v145
    v_exp_f32 v146, v146
    v_exp_f32 v147, v147
    v_exp_f32 v148, v148
    v_exp_f32 v149, v149
    v_exp_f32 v150, v150
    v_exp_f32 v151, v151
    v_pk_mul_f32 v[96:97], v[96:97], v[104:105]
    v_pk_mul_f32 v[98:99], v[98:99], v[106:107]
    v_pk_mul_f32 v[100:101], v[100:101], v[108:109]
    v_pk_mul_f32 v[102:103], v[102:103], v[110:111]
    v_pk_add_f32 v[144:145], v[144:145], 1.0 op_sel_hi:[1,0]
    v_pk_add_f32 v[146:147], v[146:147], 1.0 op_sel_hi:[1,0]
    v_pk_add_f32 v[148:149], v[148:149], 1.0 op_sel_hi:[1,0]
    v_pk_add_f32 v[150:151], v[150:151], 1.0 op_sel_hi:[1,0]
    v_rcp_f32 v144, v144
    v_rcp_f32 v145, v145
    v_rcp_f32 v146, v146
    v_rcp_f32 v147, v147
    v_rcp_f32 v148, v148
    v_rcp_f32 v149, v149
    v_rcp_f32 v150, v150
    v_rcp_f32 v151, v151
    v_pk_mul_f32 v[96:97], v[96:97], v[144:145]
    v_pk_mul_f32 v[98:99], v[98:99], v[146:147]
    v_pk_mul_f32 v[100:101], v[100:101], v[148:149]
    v_pk_mul_f32 v[102:103], v[102:103], v[150:151]
    v_cvt_pk_bf16_f32 v152, v96, v97
    v_cvt_pk_bf16_f32 v153, v98, v99
    v_cvt_pk_bf16_f32 v154, v100, v101
    v_cvt_pk_bf16_f32 v155, v102, v103
    buffer_store_dwordx4 v[152:155], v13, s[12:15], 0 offen offset:1024 sc1
    v_pk_mul_f32 v[128:129], v[64:65], v[64:65]
    v_pk_mul_f32 v[130:131], v[66:67], v[66:67]
    v_pk_mul_f32 v[132:133], v[68:69], v[68:69]
    v_pk_mul_f32 v[134:135], v[70:71], v[70:71]
    v_pk_fma_f32 v[128:129], v[128:129], v[18:19], v[16:17]
    v_pk_fma_f32 v[130:131], v[130:131], v[18:19], v[16:17]
    v_pk_fma_f32 v[132:133], v[132:133], v[18:19], v[16:17]
    v_pk_fma_f32 v[134:135], v[134:135], v[18:19], v[16:17]
    v_pk_mul_f32 v[128:129], v[128:129], v[64:65]
    v_pk_mul_f32 v[130:131], v[130:131], v[66:67]
    v_pk_mul_f32 v[132:133], v[132:133], v[68:69]
    v_pk_mul_f32 v[134:135], v[134:135], v[70:71]
    v_exp_f32 v128, v128
    v_exp_f32 v129, v129
    v_exp_f32 v130, v130
    v_exp_f32 v131, v131
    v_exp_f32 v132, v132
    v_exp_f32 v133, v133
    v_exp_f32 v134, v134
    v_exp_f32 v135, v135
    v_pk_mul_f32 v[64:65], v[64:65], v[72:73]
    v_pk_mul_f32 v[66:67], v[66:67], v[74:75]
    v_pk_mul_f32 v[68:69], v[68:69], v[76:77]
    v_pk_mul_f32 v[70:71], v[70:71], v[78:79]
    v_pk_add_f32 v[128:129], v[128:129], 1.0 op_sel_hi:[1,0]
    v_pk_add_f32 v[130:131], v[130:131], 1.0 op_sel_hi:[1,0]
    v_pk_add_f32 v[132:133], v[132:133], 1.0 op_sel_hi:[1,0]
    v_pk_add_f32 v[134:135], v[134:135], 1.0 op_sel_hi:[1,0]
    v_rcp_f32 v128, v128
    v_rcp_f32 v129, v129
    v_rcp_f32 v130, v130
    v_rcp_f32 v131, v131
    v_rcp_f32 v132, v132
    v_rcp_f32 v133, v133
    v_rcp_f32 v134, v134
    v_rcp_f32 v135, v135
    v_pk_mul_f32 v[64:65], v[64:65], v[128:129]
    v_pk_mul_f32 v[66:67], v[66:67], v[130:131]
    v_pk_mul_f32 v[68:69], v[68:69], v[132:133]
    v_pk_mul_f32 v[70:71], v[70:71], v[134:135]
    v_cvt_pk_bf16_f32 v136, v64, v65
    v_cvt_pk_bf16_f32 v137, v66, v67
    v_cvt_pk_bf16_f32 v138, v68, v69
    v_cvt_pk_bf16_f32 v139, v70, v71
    buffer_store_dwordx4 v[136:139], v14, s[12:15], 0 offen offset:0 sc1
    v_pk_mul_f32 v[144:145], v[112:113], v[112:113]
    v_pk_mul_f32 v[146:147], v[114:115], v[114:115]
    v_pk_mul_f32 v[148:149], v[116:117], v[116:117]
    v_pk_mul_f32 v[150:151], v[118:119], v[118:119]
    v_pk_fma_f32 v[144:145], v[144:145], v[18:19], v[16:17]
    v_pk_fma_f32 v[146:147], v[146:147], v[18:19], v[16:17]
    v_pk_fma_f32 v[148:149], v[148:149], v[18:19], v[16:17]
    v_pk_fma_f32 v[150:151], v[150:151], v[18:19], v[16:17]
    v_pk_mul_f32 v[144:145], v[144:145], v[112:113]
    v_pk_mul_f32 v[146:147], v[146:147], v[114:115]
    v_pk_mul_f32 v[148:149], v[148:149], v[116:117]
    v_pk_mul_f32 v[150:151], v[150:151], v[118:119]
    v_exp_f32 v144, v144
    v_exp_f32 v145, v145
    v_exp_f32 v146, v146
    v_exp_f32 v147, v147
    v_exp_f32 v148, v148
    v_exp_f32 v149, v149
    v_exp_f32 v150, v150
    v_exp_f32 v151, v151
    v_pk_mul_f32 v[112:113], v[112:113], v[120:121]
    v_pk_mul_f32 v[114:115], v[114:115], v[122:123]
    v_pk_mul_f32 v[116:117], v[116:117], v[124:125]
    v_pk_mul_f32 v[118:119], v[118:119], v[126:127]
    v_pk_add_f32 v[144:145], v[144:145], 1.0 op_sel_hi:[1,0]
    v_pk_add_f32 v[146:147], v[146:147], 1.0 op_sel_hi:[1,0]
    v_pk_add_f32 v[148:149], v[148:149], 1.0 op_sel_hi:[1,0]
    v_pk_add_f32 v[150:151], v[150:151], 1.0 op_sel_hi:[1,0]
    v_rcp_f32 v144, v144
    v_rcp_f32 v145, v145
    v_rcp_f32 v146, v146
    v_rcp_f32 v147, v147
    v_rcp_f32 v148, v148
    v_rcp_f32 v149, v149
    v_rcp_f32 v150, v150
    v_rcp_f32 v151, v151
    v_pk_mul_f32 v[112:113], v[112:113], v[144:145]
    v_pk_mul_f32 v[114:115], v[114:115], v[146:147]
    v_pk_mul_f32 v[116:117], v[116:117], v[148:149]
    v_pk_mul_f32 v[118:119], v[118:119], v[150:151]
    v_cvt_pk_bf16_f32 v152, v112, v113
    v_cvt_pk_bf16_f32 v153, v114, v115
    v_cvt_pk_bf16_f32 v154, v116, v117
    v_cvt_pk_bf16_f32 v155, v118, v119
    buffer_store_dwordx4 v[152:155], v14, s[12:15], 0 offen offset:1024 sc1
K_b1:
    s_lshr_b32 s50, s3, 2
    s_and_b32 s51, s3, 3
    s_lshl_b32 s73, s4, 2
    s_and_b32 s8, s5, 3
    s_add_u32 s73, s73, s8
    s_mul_i32 s53, s50, 16640
    s_add_u32 s53, s53, 49152
    v_and_b32 v6, 15, v0
    v_lshrrev_b32 v4, 5, v0
    v_and_b32 v14, 31, v0
    v_sub_u32 v8, 3, v14
    v_and_b32 v8, 3, v8
    v_mul_u32_u24 v12, 4160, v8
    v_lshrrev_b32 v8, 2, v14
    v_lshlrev_b32 v9, 1, v4
    v_sub_u32 v8, v9, v8
    v_lshl_add_u32 v12, v8, 3, v12
    s_lshl_b32 s68, s51, 9
    s_sub_u32 s68, s53, s68
    s_add_u32 s68, s68, 1592
    v_add_u32 v12, s68, v12
    v_mul_u32_u24 v13, 80, v14
    v_lshl_add_u32 v13, v4, 4, v13
    s_mul_i32 s52, s50, 7680
    s_add_u32 s52, s52, 32768
    s_mul_i32 s68, s51, 640
    s_sub_u32 s68, s52, s68
    s_add_u32 s68, s68, 2000
    v_add_u32 v13, s68, v13
    s_mul_i32 s10, s73, 176128
    s_add_u32 s8, s48, s10
    s_addc_u32 s9, s49, 0
    s_mov_b32 s10, 176128
    s_mov_b32 s11, 0x20000
    s_lshl_b32 s68, s2, 7
    s_lshl_b32 s69, s3, 2
    s_add_u32 s68, s68, s69
    s_add_u32 s68, s68, 32768
    s_cmp_lt_u32 s3, 4
    s_cselect_b32 s68, s68, 0x100000
    v_lshl_add_u32 v1, v0, 20, s68
    v_mov_b32 v7, 1
    s_lshr_b32 s68, s73, 1
    s_and_b32 s69, s68, 7
    s_lshl_b32 s69, s69, 10
    s_lshr_b32 s68, s68, 3
    s_lshl_b32 s68, s68, 9
    s_add_u32 s68, s68, s69
    s_add_u32 s68, s68, 32768
    v_mov_b32 v4, 1
    v_lshrrev_b32 v2, 4, v0
    v_lshlrev_b32 v2, 13, v2
    v_bfe_u32 v3, v0, 2, 2
    v_lshl_add_u32 v2, v3, 7, v2
    v_and_b32 v3, 3, v0
    v_lshl_add_u32 v2, v3, 2, v2
    v_add_u32 v2, s68, v2
    s_add_u32 s68, s3, 0
    s_and_b32 s68, s68, 7
    s_mul_i32 s68, s68, 22528
    v_lshl_add_u32 v10, v0, 4, s68
    s_waitcnt lgkmcnt(0)
    s_barrier
    ds_read_b128 v[56:59], v13 offset:560
    ds_read_b64 v[48:49], v12 offset:2496
    ds_read_b64 v[50:51], v12 offset:2504
    ds_read_b128 v[60:63], v13 offset:3120
    ds_read_b64 v[52:53], v12 offset:448
    ds_read_b64 v[54:55], v12 offset:456
    s_waitcnt vmcnt(0)
    buffer_store_dword v7, v1, s[64:67], 0 offen sc1
    s_waitcnt lgkmcnt(0)
    v_mfma_f32_32x32x16_bf16 v[16:31], v[48:51], v[56:59], 0
    ds_read_b128 v[72:75], v13 offset:592
    ds_read_b64 v[64:65], v12 offset:2528
    ds_read_b64 v[66:67], v12 offset:2536
    v_mfma_f32_32x32x16_bf16 v[32:47], v[48:51], v[60:63], 0
    ds_read_b128 v[76:79], v13 offset:3152
    ds_read_b64 v[68:69], v12 offset:480
    ds_read_b64 v[70:71], v12 offset:488
    v_mfma_f32_32x32x16_bf16 v[32:47], v[52:55], v[56:59], v[32:47]
    s_add_u32 s96, s96, 16384
    s_cmp_eq_u32 s96, 180224
    s_cselect_b32 s96, 0, s96
    v_add_u32 v15, s96, v11
    buffer_load_dwordx4 v[200:203], v15, s[60:63], 0 offen sc1
    buffer_load_dwordx4 v[204:207], v15, s[60:63], 0 offen offset:1024 sc1
    s_waitcnt lgkmcnt(0)
    v_mfma_f32_32x32x16_bf16 v[16:31], v[64:67], v[72:75], v[16:31]
    ds_read_b128 v[56:59], v13 offset:480
    ds_read_b64 v[48:49], v12 offset:2432
    ds_read_b64 v[50:51], v12 offset:2440
    v_mfma_f32_32x32x16_bf16 v[32:47], v[64:67], v[76:79], v[32:47]
    ds_read_b128 v[60:63], v13 offset:3040
    ds_read_b64 v[52:53], v12 offset:384
    ds_read_b64 v[54:55], v12 offset:392
    v_mfma_f32_32x32x16_bf16 v[32:47], v[68:71], v[72:75], v[32:47]
    s_add_u32 s96, s96, 16384
    s_cmp_eq_u32 s96, 180224
    s_cselect_b32 s96, 0, s96
    v_add_u32 v15, s96, v11
    buffer_load_dwordx4 v[208:211], v15, s[60:63], 0 offen sc1
    buffer_load_dwordx4 v[212:215], v15, s[60:63], 0 offen offset:1024 sc1
    s_waitcnt lgkmcnt(0)
    v_mfma_f32_32x32x16_bf16 v[16:31], v[48:51], v[56:59], v[16:31]
    ds_read_b128 v[72:75], v13 offset:512
    ds_read_b64 v[64:65], v12 offset:2464
    ds_read_b64 v[66:67], v12 offset:2472
    v_mfma_f32_32x32x16_bf16 v[32:47], v[48:51], v[60:63], v[32:47]
    ds_read_b128 v[76:79], v13 offset:3072
    ds_read_b64 v[68:69], v12 offset:416
    ds_read_b64 v[70:71], v12 offset:424
    v_mfma_f32_32x32x16_bf16 v[32:47], v[52:55], v[56:59], v[32:47]
    s_add_u32 s96, s96, 16384
    s_cmp_eq_u32 s96, 180224
    s_cselect_b32 s96, 0, s96
    v_add_u32 v15, s96, v11
    buffer_load_dwordx4 v[216:219], v15, s[60:63], 0 offen sc1
    buffer_load_dwordx4 v[220:223], v15, s[60:63], 0 offen offset:1024 sc1
    s_waitcnt lgkmcnt(0)
    v_mfma_f32_32x32x16_bf16 v[16:31], v[64:67], v[72:75], v[16:31]
    ds_read_b128 v[56:59], v13 offset:400
    ds_read_b64 v[48:49], v12 offset:2368
    ds_read_b64 v[50:51], v12 offset:2376
    v_mfma_f32_32x32x16_bf16 v[32:47], v[64:67], v[76:79], v[32:47]
    ds_read_b128 v[60:63], v13 offset:2960
    ds_read_b64 v[52:53], v12 offset:320
    ds_read_b64 v[54:55], v12 offset:328
    v_mfma_f32_32x32x16_bf16 v[32:47], v[68:71], v[72:75], v[32:47]
    s_add_u32 s96, s96, 16384
    s_cmp_eq_u32 s96, 180224
    s_cselect_b32 s96, 0, s96
    v_add_u32 v15, s96, v11
    buffer_load_dwordx4 v[224:227], v15, s[60:63], 0 offen sc1
    buffer_load_dwordx4 v[228:231], v15, s[60:63], 0 offen offset:1024 sc1
    s_waitcnt lgkmcnt(0)
    v_mfma_f32_32x32x16_bf16 v[16:31], v[48:51], v[56:59], v[16:31]
    ds_read_b128 v[72:75], v13 offset:432
    ds_read_b64 v[64:65], v12 offset:2400
    ds_read_b64 v[66:67], v12 offset:2408
    v_mfma_f32_32x32x16_bf16 v[32:47], v[48:51], v[60:63], v[32:47]
    ds_read_b128 v[76:79], v13 offset:2992
    ds_read_b64 v[68:69], v12 offset:352
    ds_read_b64 v[70:71], v12 offset:360
    v_mfma_f32_32x32x16_bf16 v[32:47], v[52:55], v[56:59], v[32:47]
    s_add_u32 s96, s96, 16384
    s_cmp_eq_u32 s96, 180224
    s_cselect_b32 s96, 0, s96
    v_add_u32 v15, s96, v11
    buffer_load_dwordx4 v[232:235], v15, s[60:63], 0 offen sc1
    buffer_load_dwordx4 v[236:239], v15, s[60:63], 0 offen offset:1024 sc1
    s_waitcnt lgkmcnt(0)
    v_mfma_f32_32x32x16_bf16 v[16:31], v[64:67], v[72:75], v[16:31]
    ds_read_b128 v[56:59], v13 offset:320
    ds_read_b64 v[48:49], v12 offset:2304
    ds_read_b64 v[50:51], v12 offset:2312
    v_mfma_f32_32x32x16_bf16 v[32:47], v[64:67], v[76:79], v[32:47]
    ds_read_b128 v[60:63], v13 offset:2880
    ds_read_b64 v[52:53], v12 offset:256
    ds_read_b64 v[54:55], v12 offset:264
    v_mfma_f32_32x32x16_bf16 v[32:47], v[68:71], v[72:75], v[32:47]
    s_add_u32 s96, s96, 16384
    s_cmp_eq_u32 s96, 180224
    s_cselect_b32 s96, 0, s96
    v_add_u32 v15, s96, v11
    buffer_load_dwordx4 v[240:243], v15, s[60:63], 0 offen sc1
    buffer_load_dwordx4 v[244:247], v15, s[60:63], 0 offen offset:1024 sc1
    s_waitcnt lgkmcnt(0)
    v_mfma_f32_32x32x16_bf16 v[16:31], v[48:51], v[56:59], v[16:31]
    ds_read_b128 v[72:75], v13 offset:352
    ds_read_b64 v[64:65], v12 offset:2336
    ds_read_b64 v[66:67], v12 offset:2344
    v_mfma_f32_32x32x16_bf16 v[32:47], v[48:51], v[60:63], v[32:47]
    ds_read_b128 v[76:79], v13 offset:2912
    ds_read_b64 v[68:69], v12 offset:288
    ds_read_b64 v[70:71], v12 offset:296
    v_mfma_f32_32x32x16_bf16 v[32:47], v[52:55], v[56:59], v[32:47]
    s_add_u32 s96, s96, 16384
    s_cmp_eq_u32 s96, 180224
    s_cselect_b32 s96, 0, s96
    v_add_u32 v15, s96, v11
    buffer_load_dwordx4 v[248:251], v15, s[60:63], 0 offen sc1
    buffer_load_dwordx4 v[252:255], v15, s[60:63], 0 offen offset:1024 sc1
    s_waitcnt lgkmcnt(0)
    v_mfma_f32_32x32x16_bf16 v[16:31], v[64:67], v[72:75], v[16:31]
    ds_read_b128 v[56:59], v13 offset:240
    ds_read_b64 v[48:49], v12 offset:2240
    ds_read_b64 v[50:51], v12 offset:2248
    v_mfma_f32_32x32x16_bf16 v[32:47], v[64:67], v[76:79], v[32:47]
    ds_read_b128 v[60:63], v13 offset:2800
    ds_read_b64 v[52:53], v12 offset:192
    ds_read_b64 v[54:55], v12 offset:200
    v_mfma_f32_32x32x16_bf16 v[32:47], v[68:71], v[72:75], v[32:47]
    s_waitcnt lgkmcnt(0)
    v_mfma_f32_32x32x16_bf16 v[16:31], v[48:51], v[56:59], v[16:31]
    ds_read_b128 v[72:75], v13 offset:272
    ds_read_b64 v[64:65], v12 offset:2272
    ds_read_b64 v[66:67], v12 offset:2280
    v_mfma_f32_32x32x16_bf16 v[32:47], v[48:51], v[60:63], v[32:47]
    ds_read_b128 v[76:79], v13 offset:2832
    ds_read_b64 v[68:69], v12 offset:224
    ds_read_b64 v[70:71], v12 offset:232
    v_mfma_f32_32x32x16_bf16 v[32:47], v[52:55], v[56:59], v[32:47]
    s_waitcnt lgkmcnt(0)
    v_mfma_f32_32x32x16_bf16 v[16:31], v[64:67], v[72:75], v[16:31]
    ds_read_b128 v[56:59], v13 offset:160
    ds_read_b64 v[48:49], v12 offset:2176
    ds_read_b64 v[50:51], v12 offset:2184
    v_mfma_f32_32x32x16_bf16 v[32:47], v[64:67], v[76:79], v[32:47]
    ds_read_b128 v[60:63], v13 offset:2720
    ds_read_b64 v[52:53], v12 offset:128
    ds_read_b64 v[54:55], v12 offset:136
    v_mfma_f32_32x32x16_bf16 v[32:47], v[68:71], v[72:75], v[32:47]
    s_waitcnt lgkmcnt(0)
    v_mfma_f32_32x32x16_bf16 v[16:31], v[48:51], v[56:59], v[16:31]
    ds_read_b128 v[72:75], v13 offset:192
    ds_read_b64 v[64:65], v12 offset:2208
    ds_read_b64 v[66:67], v12 offset:2216
    v_mfma_f32_32x32x16_bf16 v[32:47], v[48:51], v[60:63], v[32:47]
    ds_read_b128 v[76:79], v13 offset:2752
    ds_read_b64 v[68:69], v12 offset:160
    ds_read_b64 v[70:71], v12 offset:168
    v_mfma_f32_32x32x16_bf16 v[32:47], v[52:55], v[56:59], v[32:47]
    s_waitcnt lgkmcnt(0)
    v_mfma_f32_32x32x16_bf16 v[16:31], v[64:67], v[72:75], v[16:31]
    ds_read_b128 v[56:59], v13 offset:80
    ds_read_b64 v[48:49], v12 offset:2112
    ds_read_b64 v[50:51], v12 offset:2120
    v_mfma_f32_32x32x16_bf16 v[32:47], v[64:67], v[76:79], v[32:47]
    ds_read_b128 v[60:63], v13 offset:2640
    ds_read_b64 v[52:53], v12 offset:64
    ds_read_b64 v[54:55], v12 offset:72
    v_mfma_f32_32x32x16_bf16 v[32:47], v[68:71], v[72:75], v[32:47]
    s_waitcnt lgkmcnt(0)
    v_mfma_f32_32x32x16_bf16 v[16:31], v[48:51], v[56:59], v[16:31]
    ds_read_b128 v[72:75], v13 offset:112
    ds_read_b64 v[64:65], v12 offset:2144
    ds_read_b64 v[66:67], v12 offset:2152
    v_mfma_f32_32x32x16_bf16 v[32:47], v[48:51], v[60:63], v[32:47]
    ds_read_b128 v[76:79], v13 offset:2672
    ds_read_b64 v[68:69], v12 offset:96
    ds_read_b64 v[70:71], v12 offset:104
    v_mfma_f32_32x32x16_bf16 v[32:47], v[52:55], v[56:59], v[32:47]
    buffer_load_dword v3, v2, s[64:67], 0 offen sc1
    s_waitcnt lgkmcnt(0)
    v_mfma_f32_32x32x16_bf16 v[16:31], v[64:67], v[72:75], v[16:31]
    ds_read_b128 v[56:59], v13 offset:0
    ds_read_b64 v[48:49], v12 offset:2048
    ds_read_b64 v[50:51], v12 offset:2056
    v_mfma_f32_32x32x16_bf16 v[32:47], v[64:67], v[76:79], v[32:47]
    ds_read_b128 v[60:63], v13 offset:2560
    ds_read_b64 v[52:53], v12 offset:0
    ds_read_b64 v[54:55], v12 offset:8
    v_mfma_f32_32x32x16_bf16 v[32:47], v[68:71], v[72:75], v[32:47]
    s_waitcnt lgkmcnt(0)
    v_mfma_f32_32x32x16_bf16 v[16:31], v[48:51], v[56:59], v[16:31]
    ds_read_b128 v[72:75], v13 offset:32
    ds_read_b64 v[64:65], v12 offset:2080
    ds_read_b64 v[66:67], v12 offset:2088
    v_mfma_f32_32x32x16_bf16 v[32:47], v[48:51], v[60:63], v[32:47]
    ds_read_b128 v[76:79], v13 offset:2592
    ds_read_b64 v[68:69], v12 offset:32
    ds_read_b64 v[70:71], v12 offset:40
    v_mfma_f32_32x32x16_bf16 v[32:47], v[52:55], v[56:59], v[32:47]
    s_waitcnt lgkmcnt(0)
    v_mfma_f32_32x32x16_bf16 v[16:31], v[64:67], v[72:75], v[16:31]
    v_mfma_f32_32x32x16_bf16 v[32:47], v[64:67], v[76:79], v[32:47]
    v_mfma_f32_32x32x16_bf16 v[32:47], v[68:71], v[72:75], v[32:47]
    s_lshl_b32 s68, s3, 13
    s_add_u32 s68, s68, 98304
    v_lshl_add_u32 v8, v0, 4, s68
    v_lshrrev_b32 v5, 4, v0
    v_lshlrev_b32 v9, 10, v5
    v_lshl_add_u32 v9, v6, 4, v9
    s_lshl_b32 s68, s50, 15
    s_lshr_b32 s69, s51, 1
    s_lshl_b32 s69, s69, 12
    s_add_u32 s68, s68, s69
    s_and_b32 s69, s51, 1
    s_lshl_b32 s69, s69, 8
    s_add_u32 s68, s68, s69
    s_add_u32 s68, s68, 98304
    v_add_u32 v9, s68, v9
    v_mul_u32_u24 v7, 80, v6
    v_lshl_add_u32 v7, v5, 4, v7
    s_mul_i32 s68, s51, 1280
    s_add_u32 s68, s68, s52
    v_add_u32 v7, s68, v7
    ds_read_b128 v[60:63], v7 offset:2560
    ds_write_b128 v8, v[16:19] offset:0
    ds_write_b128 v8, v[20:23] offset:1024
    ds_write_b128 v8, v[24:27] offset:2048
    ds_write_b128 v8, v[28:31] offset:3072
    ds_write_b128 v8, v[32:35] offset:4096
    ds_write_b128 v8, v[36:39] offset:5120
    ds_write_b128 v8, v[40:43] offset:6144
    ds_write_b128 v8, v[44:47] offset:7168
    s_mov_b32 s70, 0
    s_waitcnt vmcnt(0)
K_pollh:
    v_and_b32 v3, v3, v4
    v_cmp_ne_u32 vcc, v3, v4
    s_nop 4
    s_cbranch_vccz K_pollh_ok
    s_add_u32 s70, s70, 1
    s_cmp_lt_u32 s70, 0x40000
    s_cbranch_scc0 K_pollh_ok
    s_sleep 1
    buffer_load_dword v3, v2, s[64:67], 0 offen sc1
    s_waitcnt vmcnt(0)
    s_branch K_pollh
K_pollh_ok:
    s_add_u32 s97, s97, 2048
    s_cmp_eq_u32 s97, 22528
    s_cselect_b32 s97, 0, s97
    v_add_u32 v15, s97, v10
    buffer_load_dwordx4 v[80:83], v15, s[8:11], 0 offen sc1
    buffer_load_dwordx4 v[84:87], v15, s[8:11], 0 offen offset:1024 sc1
    s_add_u32 s97, s97, 2048
    s_cmp_eq_u32 s97, 22528
    s_cselect_b32 s97, 0, s97
    v_add_u32 v15, s97, v10
    buffer_load_dwordx4 v[88:91], v15, s[8:11], 0 offen sc1
    buffer_load_dwordx4 v[92:95], v15, s[8:11], 0 offen offset:1024 sc1
    s_add_u32 s97, s97, 2048
    s_cmp_eq_u32 s97, 22528
    s_cselect_b32 s97, 0, s97
    v_add_u32 v15, s97, v10
    buffer_load_dwordx4 v[96:99], v15, s[8:11], 0 offen sc1
    buffer_load_dwordx4 v[100:103], v15, s[8:11], 0 offen offset:1024 sc1
    s_add_u32 s97, s97, 2048
    s_cmp_eq_u32 s97, 22528
    s_cselect_b32 s97, 0, s97
    v_add_u32 v15, s97, v10
    buffer_load_dwordx4 v[104:107], v15, s[8:11], 0 offen sc1
    buffer_load_dwordx4 v[108:111], v15, s[8:11], 0 offen offset:1024 sc1
    s_waitcnt lgkmcnt(0)
    s_barrier
    ds_read_b128 v[16:19], v9 offset:0
    ds_read_b128 v[20:23], v9 offset:512
    ds_read_b128 v[24:27], v9 offset:8192
    ds_read_b128 v[28:31], v9 offset:8704
    ds_read_b128 v[32:35], v9 offset:16384
    ds_read_b128 v[36:39], v9 offset:16896
    ds_read_b128 v[40:43], v9 offset:24576
    ds_read_b128 v[44:47], v9 offset:25088
    s_add_u32 s60, s48, 0x1000000
    s_addc_u32 s61, s49, 0
    s_mov_b32 s62, 0x200000
    s_mov_b32 s63, 0x20000
    s_lshl_b32 s68, s98, 16
    s_and_b32 s57, s98, 0xffff0000
    s_cmp_eq_u32 s50, 0
    s_cselect_b32 s57, s68, s57
    s_add_u32 s68, s72, s50
    s_lshl_b32 s68, s68, 12
    s_lshl_b32 s69, s51, 10
    s_add_u32 s68, s68, s69
    v_lshlrev_b32 v8, 6, v6
    v_lshl_add_u32 v8, v5, 4, v8
    v_add_u32 v8, s68, v8
    v_lshlrev_b32 v48, 16, v60
    v_and_b32 v49, 0xffff0000, v60
    v_lshlrev_b32 v50, 16, v61
    v_and_b32 v51, 0xffff0000, v61
    v_lshlrev_b32 v52, 16, v62
    v_and_b32 v53, 0xffff0000, v62
    v_lshlrev_b32 v54, 16, v63
    v_and_b32 v55, 0xffff0000, v63
    s_waitcnt lgkmcnt(4)
    v_pk_add_f32 v[16:17], v[16:17], v[24:25]
    v_pk_add_f32 v[18:19], v[18:19], v[26:27]
    v_pk_add_f32 v[20:21], v[20:21], v[28:29]
    v_pk_add_f32 v[22:23], v[22:23], v[30:31]
    s_waitcnt lgkmcnt(0)
    v_pk_add_f32 v[32:33], v[32:33], v[40:41]
    v_pk_add_f32 v[34:35], v[34:35], v[42:43]
    v_pk_add_f32 v[36:37], v[36:37], v[44:45]
    v_pk_add_f32 v[38:39], v[38:39], v[46:47]
    v_fmac_f32 v16, s57, v48
    v_fmac_f32 v17, s57, v49
    v_fmac_f32 v18, s57, v50
    v_fmac_f32 v19, s57, v51
    v_fmac_f32 v20, s57, v52
    v_fmac_f32 v21, s57, v53
    v_fmac_f32 v22, s57, v54
    v_fmac_f32 v23, s57, v55
    v_pk_add_f32 v[16:17], v[16:17], v[32:33]
    v_pk_add_f32 v[18:19], v[18:19], v[34:35]
    v_pk_add_f32 v[20:21], v[20:21], v[36:37]
    v_pk_add_f32 v[22:23], v[22:23], v[38:39]
    v_cvt_pk_bf16_f32 v56, v16, v17
    v_cvt_pk_bf16_f32 v57, v18, v19
    v_cvt_pk_bf16_f32 v58, v20, v21
    v_cvt_pk_bf16_f32 v59, v22, v23
    v_min_u32 v56, 0xfffffffe, v56
    v_min_u32 v57, 0xfffffffe, v57
    v_min_u32 v58, 0xfffffffe, v58
    v_min_u32 v59, 0xfffffffe, v59
    buffer_store_dwordx4 v[56:59], v8, s[60:63], 0 offen sc1
    s_add_u32 s97, s97, 2048
    s_cmp_eq_u32 s97, 22528
    s_cselect_b32 s97, 0, s97
    v_add_u32 v15, s97, v10
    buffer_load_dwordx4 v[112:115], v15, s[8:11], 0 offen sc1
    buffer_load_dwordx4 v[116:119], v15, s[8:11], 0 offen offset:1024 sc1
    s_add_u32 s97, s97, 2048
    s_cmp_eq_u32 s97, 22528
    s_cselect_b32 s97, 0, s97
    v_add_u32 v15, s97, v10
    buffer_load_dwordx4 v[120:123], v15, s[8:11], 0 offen sc1
    buffer_load_dwordx4 v[124:127], v15, s[8:11], 0 offen offset:1024 sc1
    s_lshl_b32 s68, s73, 6
    s_lshl_b32 s69, s51, 4
    s_add_u32 s68, s68, s69
    v_add_u32 v14, s68, v6
    v_lshlrev_b32 v8, 2, v14
    v_add_u32 v8, 0xf00000, v8
    global_load_dword v13, v8, s[48:49] sc1
    s_lshl_b32 s68, s68, 1
    s_lshl_b32 s69, s71, 18
    s_add_u32 s68, s68, s69
    s_lshl_b32 s69, s50, 17
    s_add_u32 s68, s68, s69
    v_lshrrev_b32 v12, 1, v0
    v_lshlrev_b32 v12, 12, v12
    v_and_b32 v8, 1, v0
    v_lshl_add_u32 v12, v8, 4, v12
    v_add_u32 v12, s68, v12
    s_lshl_b32 s68, s71, 7
    s_lshl_b32 s69, s50, 14
    s_add_u32 s68, s68, s69
    s_lshr_b32 s69, s73, 3
    s_lshl_b32 s69, s69, 2
    s_add_u32 s68, s68, s69
    s_add_u32 s68, s68, 0
    v_bfe_u32 v2, v0, 1, 4
    v_lshlrev_b32 v2, 10, v2
    v_mov_b32 v1, 1
    v_add_u32 v2, s68, v2
    v_mov_b32 v4, 1
    v_mov_b32 v4, v12
    buffer_load_dword v3, v2, s[64:67], 0 offen sc1
    s_barrier
    s_waitcnt vmcnt(13)
    v_mfma_f32_32x32x16_bf16 v[16:31], v[168:171], v[80:83], 0
    v_mfma_f32_32x32x16_bf16 v[32:47], v[168:171], v[84:87], 0
    v_mfma_f32_32x32x16_bf16 v[48:63], v[172:175], v[80:83], 0
    v_mfma_f32_32x32x16_bf16 v[64:79], v[172:175], v[84:87], 0
    s_add_u32 s97, s97, 2048
    s_cmp_eq_u32 s97, 22528
    s_cselect_b32 s97, 0, s97
    v_add_u32 v15, s97, v10
    buffer_load_dwordx4 v[128:131], v15, s[8:11], 0 offen sc1
    buffer_load_dwordx4 v[132:135], v15, s[8:11], 0 offen offset:1024 sc1
    s_waitcnt vmcnt(13)
    v_mfma_f32_32x32x16_bf16 v[16:31], v[176:179], v[88:91], v[16:31]
    v_mfma_f32_32x32x16_bf16 v[32:47], v[176:179], v[92:95], v[32:47]
    v_mfma_f32_32x32x16_bf16 v[48:63], v[180:183], v[88:91], v[48:63]
    v_mfma_f32_32x32x16_bf16 v[64:79], v[180:183], v[92:95], v[64:79]
    s_add_u32 s97, s97, 2048
    s_cmp_eq_u32 s97, 22528
    s_cselect_b32 s97, 0, s97
    v_add_u32 v15, s97, v10
    buffer_load_dwordx4 v[136:139], v15, s[8:11], 0 offen sc1
    buffer_load_dwordx4 v[140:143], v15, s[8:11], 0 offen offset:1024 sc1
    s_waitcnt vmcnt(13)
    v_mfma_f32_32x32x16_bf16 v[16:31], v[184:187], v[96:99], v[16:31]
    v_mfma_f32_32x32x16_bf16 v[32:47], v[184:187], v[100:103], v[32:47]
    v_mfma_f32_32x32x16_bf16 v[48:63], v[188:191], v[96:99], v[48:63]
    v_mfma_f32_32x32x16_bf16 v[64:79], v[188:191], v[100:103], v[64:79]
    s_add_u32 s97, s97, 2048
    s_cmp_eq_u32 s97, 22528
    s_cselect_b32 s97, 0, s97
    v_add_u32 v15, s97, v10
    buffer_load_dwordx4 v[144:147], v15, s[8:11], 0 offen sc1
    buffer_load_dwordx4 v[148:151], v15, s[8:11], 0 offen offset:1024 sc1
    s_waitcnt vmcnt(13)
    v_mfma_f32_32x32x16_bf16 v[16:31], v[192:195], v[104:107], v[16:31]
    v_mfma_f32_32x32x16_bf16 v[32:47], v[192:195], v[108:111], v[32:47]
    v_mfma_f32_32x32x16_bf16 v[48:63], v[196:199], v[104:107], v[48:63]
    v_mfma_f32_32x32x16_bf16 v[64:79], v[196:199], v[108:111], v[64:79]
    s_add_u32 s97, s97, 2048
    s_cmp_eq_u32 s97, 22528
    s_cselect_b32 s97, 0, s97
    v_add_u32 v15, s97, v10
    buffer_load_dwordx4 v[152:155], v15, s[8:11], 0 offen sc1
    buffer_load_dwordx4 v[156:159], v15, s[8:11], 0 offen offset:1024 sc1
    s_waitcnt vmcnt(12)
    v_mfma_f32_32x32x16_bf16 v[16:31], v[200:203], v[112:115], v[16:31]
    v_mfma_f32_32x32x16_bf16 v[32:47], v[200:203], v[116:119], v[32:47]
    v_mfma_f32_32x32x16_bf16 v[48:63], v[204:207], v[112:115], v[48:63]
    v_mfma_f32_32x32x16_bf16 v[64:79], v[204:207], v[116:119], v[64:79]
    s_add_u32 s97, s97, 2048
    s_cmp_eq_u32 s97, 22528
    s_cselect_b32 s97, 0, s97
    v_add_u32 v15, s97, v10
    buffer_load_dwordx4 v[160:163], v15, s[8:11], 0 offen sc1
    buffer_load_dwordx4 v[164:167], v15, s[8:11], 0 offen offset:1024 sc1
    s_waitcnt vmcnt(12)
    v_mfma_f32_32x32x16_bf16 v[16:31], v[208:211], v[120:123], v[16:31]
    v_mfma_f32_32x32x16_bf16 v[32:47], v[208:211], v[124:127], v[32:47]
    v_mfma_f32_32x32x16_bf16 v[48:63], v[212:215], v[120:123], v[48:63]
    v_mfma_f32_32x32x16_bf16 v[64:79], v[212:215], v[124:127], v[64:79]
    s_waitcnt vmcnt(8)
    v_mfma_f32_32x32x16_bf16 v[16:31], v[216:219], v[128:131], v[16:31]
    v_mfma_f32_32x32x16_bf16 v[32:47], v[216:219], v[132:135], v[32:47]
    v_mfma_f32_32x32x16_bf16 v[48:63], v[220:223], v[128:131], v[48:63]
    v_mfma_f32_32x32x16_bf16 v[64:79], v[220:223], v[132:135], v[64:79]
    s_waitcnt vmcnt(6)
    v_mfma_f32_32x32x16_bf16 v[16:31], v[224:227], v[136:139], v[16:31]
    v_mfma_f32_32x32x16_bf16 v[32:47], v[224:227], v[140:143], v[32:47]
    v_mfma_f32_32x32x16_bf16 v[48:63], v[228:231], v[136:139], v[48:63]
    v_mfma_f32_32x32x16_bf16 v[64:79], v[228:231], v[140:143], v[64:79]
    s_waitcnt vmcnt(4)
    v_mfma_f32_32x32x16_bf16 v[16:31], v[232:235], v[144:147], v[16:31]
    v_mfma_f32_32x32x16_bf16 v[32:47], v[232:235], v[148:151], v[32:47]
    v_mfma_f32_32x32x16_bf16 v[48:63], v[236:239], v[144:147], v[48:63]
    v_mfma_f32_32x32x16_bf16 v[64:79], v[236:239], v[148:151], v[64:79]
    s_waitcnt vmcnt(2)
    v_mfma_f32_32x32x16_bf16 v[16:31], v[240:243], v[152:155], v[16:31]
    v_mfma_f32_32x32x16_bf16 v[32:47], v[240:243], v[156:159], v[32:47]
    v_mfma_f32_32x32x16_bf16 v[48:63], v[244:247], v[152:155], v[48:63]
    v_mfma_f32_32x32x16_bf16 v[64:79], v[244:247], v[156:159], v[64:79]
    s_waitcnt vmcnt(0)
    v_mfma_f32_32x32x16_bf16 v[16:31], v[248:251], v[160:163], v[16:31]
    v_mfma_f32_32x32x16_bf16 v[32:47], v[248:251], v[164:167], v[32:47]
    v_mfma_f32_32x32x16_bf16 v[48:63], v[252:255], v[160:163], v[48:63]
    v_mfma_f32_32x32x16_bf16 v[64:79], v[252:255], v[164:167], v[64:79]
    s_mov_b32 s70, 0
    s_waitcnt vmcnt(10)
K_pf:
    v_and_b32 v3, v3, v1
    v_cmp_ne_u32 vcc, v3, v1
    s_nop 4
    s_cbranch_vccz K_pf_ok
    s_add_u32 s70, s70, 1
    s_cmp_lt_u32 s70, 0x40000
    s_cbranch_scc0 K_pf_ok
    s_sleep 1
    buffer_load_dword v3, v2, s[64:67], 0 offen sc1
    s_waitcnt vmcnt(0)
    s_branch K_pf
K_pf_ok:
    buffer_load_dwordx4 v[80:83], v4, s[60:63], 0 offen sc1
    s_lshl_b32 s68, s3, 14
    v_lshl_add_u32 v8, v0, 4, s68
    v_lshlrev_b32 v9, 10, v5
    v_lshl_add_u32 v9, v6, 4, v9
    s_lshl_b32 s68, s50, 13
    s_lshr_b32 s69, s51, 1
    s_lshl_b32 s69, s69, 12
    s_add_u32 s68, s68, s69
    s_and_b32 s69, s51, 1
    s_lshl_b32 s69, s69, 8
    s_add_u32 s68, s68, s69
    v_add_u32 v9, s68, v9
    v_add_u32 v10, 0x10000, v9
    ds_write_b128 v8, v[16:19] offset:0
    ds_write_b128 v8, v[20:23] offset:1024
    ds_write_b128 v8, v[24:27] offset:2048
    ds_write_b128 v8, v[28:31] offset:3072
    ds_write_b128 v8, v[32:35] offset:4096
    ds_write_b128 v8, v[36:39] offset:5120
    ds_write_b128 v8, v[40:43] offset:6144
    ds_write_b128 v8, v[44:47] offset:7168
    ds_write_b128 v8, v[48:51] offset:8192
    ds_write_b128 v8, v[52:55] offset:9216
    ds_write_b128 v8, v[56:59] offset:10240
    ds_write_b128 v8, v[60:63] offset:11264
    ds_write_b128 v8, v[64:67] offset:12288
    ds_write_b128 v8, v[68:71] offset:13312
    ds_write_b128 v8, v[72:75] offset:14336
    ds_write_b128 v8, v[76:79] offset:15360
    s_waitcnt lgkmcnt(0)
    s_barrier
    ds_read_b128 v[16:19], v9 offset:0
    ds_read_b128 v[20:23], v9 offset:512
    ds_read_b128 v[24:27], v9 offset:16384
    ds_read_b128 v[28:31], v9 offset:16896
    ds_read_b128 v[32:35], v9 offset:32768
    ds_read_b128 v[36:39], v9 offset:33280
    ds_read_b128 v[40:43], v9 offset:49152
    ds_read_b128 v[44:47], v9 offset:49664
    ds_read_b128 v[48:51], v10 offset:0
    ds_read_b128 v[52:55], v10 offset:512
    ds_read_b128 v[56:59], v10 offset:16384
    ds_read_b128 v[60:63], v10 offset:16896
    ds_read_b128 v[64:67], v10 offset:32768
    ds_read_b128 v[68:71], v10 offset:33280
    ds_read_b128 v[72:75], v10 offset:49152
    ds_read_b128 v[76:79], v10 offset:49664
    s_mov_b32 s8, s44
    s_mov_b32 s9, s45
    s_mov_b32 s10, 0x200000
    s_mov_b32 s11, 0x20000
    s_lshl_b32 s68, s3, 10
    s_add_u32 s68, s68, 131072
    v_lshl_add_u32 v7, v0, 4, s68
    v_lshrrev_b32 v11, 2, v6
    v_lshl_add_u32 v11, v5, 3, v11
    v_lshlrev_b32 v11, 5, v11
    v_and_b32 v8, 3, v6
    v_lshl_add_u32 v11, v8, 3, v11
    v_add_u32 v11, s68, v11
    v_sub_f32 v2, 1.0, v13
    v_cvt_pk_bf16_f32 v2, v2, v2
    v_and_b32 v2, 0xffff0000, v2
    v_mov_b32 v3, v2
    v_mov_b32 v12, v13
    s_lshl_b32 s68, s71, 7
    s_lshl_b32 s69, s50, 6
    s_add_u32 s68, s68, s69
    v_lshlrev_b32 v8, 10, v14
    v_lshl_add_u32 v8, v5, 4, v8
    v_add_u32 v8, s68, v8
    s_waitcnt lgkmcnt(12)
    v_pk_add_f32 v[16:17], v[16:17], v[24:25]
    v_pk_add_f32 v[18:19], v[18:19], v[26:27]
    v_pk_add_f32 v[20:21], v[20:21], v[28:29]
    v_pk_add_f32 v[22:23], v[22:23], v[30:31]
    s_waitcnt lgkmcnt(10)
    v_pk_add_f32 v[16:17], v[16:17], v[32:33]
    v_pk_add_f32 v[18:19], v[18:19], v[34:35]
    v_pk_add_f32 v[20:21], v[20:21], v[36:37]
    v_pk_add_f32 v[22:23], v[22:23], v[38:39]
    s_waitcnt lgkmcnt(8)
    v_pk_add_f32 v[16:17], v[16:17], v[40:41]
    v_pk_add_f32 v[18:19], v[18:19], v[42:43]
    v_pk_add_f32 v[20:21], v[20:21], v[44:45]
    v_pk_add_f32 v[22:23], v[22:23], v[46:47]
    s_waitcnt lgkmcnt(6)
    v_pk_add_f32 v[16:17], v[16:17], v[48:49]
    v_pk_add_f32 v[18:19], v[18:19], v[50:51]
    v_pk_add_f32 v[20:21], v[20:21], v[52:53]
    v_pk_add_f32 v[22:23], v[22:23], v[54:55]
    s_waitcnt lgkmcnt(4)
    v_pk_add_f32 v[16:17], v[16:17], v[56:57]
    v_pk_add_f32 v[18:19], v[18:19], v[58:59]
    v_pk_add_f32 v[20:21], v[20:21], v[60:61]
    v_pk_add_f32 v[22:23], v[22:23], v[62:63]
    s_waitcnt lgkmcnt(2)
    v_pk_add_f32 v[16:17], v[16:17], v[64:65]
    v_pk_add_f32 v[18:19], v[18:19], v[66:67]
    v_pk_add_f32 v[20:21], v[20:21], v[68:69]
    v_pk_add_f32 v[22:23], v[22:23], v[70:71]
    s_waitcnt lgkmcnt(0)
    v_pk_add_f32 v[16:17], v[16:17], v[72:73]
    v_pk_add_f32 v[18:19], v[18:19], v[74:75]
    v_pk_add_f32 v[20:21], v[20:21], v[76:77]
    v_pk_add_f32 v[22:23], v[22:23], v[78:79]
    v_pk_mul_f32 v[16:17], v[16:17], v[2:3]
    v_pk_mul_f32 v[18:19], v[18:19], v[2:3]
    v_pk_mul_f32 v[20:21], v[20:21], v[2:3]
    v_pk_mul_f32 v[22:23], v[22:23], v[2:3]
    s_mov_b32 s70, 0
K_pa:
    s_waitcnt vmcnt(0)
    v_max3_u32 v1, v80, v81, v82
    v_max_u32 v1, v1, v83
    v_cmp_eq_u32 vcc, -1, v1
    s_nop 4
    s_cbranch_vccz K_pa_ok
    s_add_u32 s70, s70, 1
    s_cmp_lt_u32 s70, 0x40000
    s_cbranch_scc0 K_pa_ok
    buffer_load_dwordx4 v[80:83], v4, s[60:63], 0 offen sc1
    s_branch K_pa
K_pa_ok:
    s_waitcnt vmcnt(0)
    ds_write_b128 v7, v[80:83]
    s_waitcnt lgkmcnt(0)
    ds_read_b64_tr_b16 v[84:85], v11
    ds_read_b64_tr_b16 v[86:87], v11 offset:128
    s_waitcnt lgkmcnt(0)
    v_lshlrev_b32 v24, 16, v84
    v_and_b32 v25, 0xffff0000, v84
    v_lshlrev_b32 v26, 16, v85
    v_and_b32 v27, 0xffff0000, v85
    v_lshlrev_b32 v28, 16, v86
    v_and_b32 v29, 0xffff0000, v86
    v_lshlrev_b32 v30, 16, v87
    v_and_b32 v31, 0xffff0000, v87
    v_pk_fma_f32 v[16:17], v[24:25], v[12:13], v[16:17]
    v_pk_fma_f32 v[18:19], v[26:27], v[12:13], v[18:19]
    v_pk_fma_f32 v[20:21], v[28:29], v[12:13], v[20:21]
    v_pk_fma_f32 v[22:23], v[30:31], v[12:13], v[22:23]
    v_cvt_pk_bf16_f32 v32, v16, v17
    v_cvt_pk_bf16_f32 v33, v18, v19
    v_cvt_pk_bf16_f32 v34, v20, v21
    v_cvt_pk_bf16_f32 v35, v22, v23
    buffer_store_dwordx4 v[32:35], v8, s[8:11], 0 offen sc0 sc1
K_done:
    s_endpgm
.section .rodata,"a"
.p2align 6
.amdhsa_kernel gated_mix__ssm_conv_s4__geglu_ffn__prompt_kernel
  .amdhsa_next_free_vgpr 256
  .amdhsa_next_free_sgpr 100
  .amdhsa_accum_offset 256
  .amdhsa_group_segment_fixed_size 0
  .amdhsa_kernarg_size 136
  .amdhsa_user_sgpr_count 2
  .amdhsa_user_sgpr_kernarg_segment_ptr 1
  .amdhsa_system_sgpr_workgroup_id_x 1
.end_amdhsa_kernel
```
